```python
import torch

def _softmax(x, axis=-1):
    return torch.softmax(x, dim=axis)

def _gelu(x):
    return torch.nn.functional.gelu(x, approximate='tanh')

def _silu(x):
    return torch.nn.functional.silu(x)

def _sigmoid(x):
    return torch.sigmoid(x)

def _layernorm(x, axis=-1, eps=1e-05):
    m = x.mean(dim=axis, keepdim=True)
    v = x.var(dim=axis, keepdim=True, unbiased=False)
    return (x - m) / torch.sqrt(v + eps)

def _scatter_add(tgt, idx, src, axis=0):
    return tgt.clone().index_add_(axis, idx, src)

def _segment_sum(src, seg, n):
    out = torch.zeros((n,) + src.shape[1:], dtype=src.dtype)
    return out.index_add_(0, seg, src)

def _pad(x, pw):
    flat = tuple((v for pair in reversed(pw) for v in pair))
    return torch.nn.functional.pad(x, flat)
kernel_name = 'adaLN_cond__ssm_conv_h3__mixer_channel_mlp__prompt'

def setup_inputs():

    _w = lambda a: (lambda t: t.to(torch.bfloat16) if t.is_floating_point() else t)(torch.as_tensor(a))

    def _A_setup():
        B, S, D = (1, 2048, 1024)
        ks = 4
        return {'q': _w((lambda *s: torch.randn(*s, dtype=torch.bfloat16) * 0.05)(B, S, D)), 'k': _w((lambda *s: torch.randn(*s, dtype=torch.bfloat16) * 0.4)(B, S, D)), 'v': _w((lambda *s: torch.randn(*s, dtype=torch.bfloat16) * 0.4)(B, S, D)), 'shift_k': _w((lambda *s: torch.randn(*s, dtype=torch.bfloat16) * 0.4)(D, ks) * 0.5), 'ssm_k': _w((lambda *s: torch.randn(*s, dtype=torch.bfloat16) * 0.4)(D, S) * (1.0 / S ** 0.5)), 'ssm_D': _w((lambda *s: torch.randn(*s, dtype=torch.bfloat16) * 0.4)(D))}
    _A_in = _A_setup()

    def _B_setup():
        B, S, D, F = (1, 2048, 1024, 3584)
        return {'x': _w((lambda *s: torch.randn(*s, dtype=torch.bfloat16) * 0.05)(B, S, D)), 'w1': _w((lambda *s: torch.randn(*s, dtype=torch.bfloat16) * 3.2)(D, F) * D ** (-0.5)), 'b1': _w((lambda *s: torch.randn(*s, dtype=torch.bfloat16) * 1.6)(F)), 'w2': _w((lambda *s: torch.randn(*s, dtype=torch.bfloat16) * 0.2)(F, D) * F ** (-0.5)), 'b2': _w((lambda *s: torch.randn(*s, dtype=torch.bfloat16) * 0.4)(D))}
    _B_in = _B_setup()
    return {'A_q': _A_in['q'], 'A_k': _A_in['k'], 'A_v': _A_in['v'], 'A_shift_k': _A_in['shift_k'], 'A_ssm_k': _A_in['ssm_k'], 'A_ssm_D': _A_in['ssm_D'], 'B_x': _B_in['x'], 'B_w1': _B_in['w1'], 'B_b1': _B_in['b1'], 'B_w2': _B_in['w2'], 'B_b2': _B_in['b2'], 'c': _w((lambda *s: torch.randn(*s, dtype=torch.bfloat16) * 0.2)(1, 1024) * 8.0), 'w_mod': _w((lambda *s: torch.randn(*s, dtype=torch.bfloat16) * 0.2)(1024, 6 * 1024) * 1024 ** (-0.5) * 8.0)}

def reference(A_q, A_k, A_v, A_shift_k, A_ssm_k, A_ssm_D, B_x, B_w1, B_b1, B_w2, B_b2, c, w_mod):

    def _A_ref(q, k, v, shift_k, ssm_k, ssm_D):
        B, S, D = q.shape
        ks = shift_k.shape[-1]
        k_pad = _pad(k, ((0, 0), (ks - 1, 0), (0, 0)))
        k_shift = torch.zeros_like(k)
        for t in range(ks):
            k_shift = k_shift + k_pad[:, t:t + S, :] * shift_k[:, ks - 1 - t][None, None, :]
        kv = k_shift * v
        L = 2 * S
        kv_pad = _pad(kv, ((0, 0), (0, S), (0, 0)))
        kf_pad = _pad(ssm_k, ((0, 0), (0, S)))
        kv_f = (lambda x, axes=(-2, -1): torch.fft.rfft2(x.float(), dim=axes))(kv_pad[:, None, :, :], axes=(1, 2))
        kf_f = (lambda x, axes=(-2, -1): torch.fft.rfft2(x.float(), dim=axes))(kf_pad[:, None, :], axes=(1, 2))
        kf_f = (lambda x, *d: x.permute(*d))(kf_f, 1, 2, 0)
        y_f = kv_f * kf_f[None, :, :, :]
        y = (lambda x, s, axes=(-2, -1): torch.fft.irfft2(x, s=s, dim=axes).to(torch.bfloat16))(y_f, (1, L), axes=(1, 2))[:, 0, :S, :]
        y = y + kv * ssm_D[None, None, :]
        return q * y

    def _B_ref(x, w1, b1, w2, b2):
        y = _layernorm(x, axis=-1)
        h = _gelu(torch.einsum('bsd,df->bsf', y, w1) + b1)
        return torch.einsum('bsf,fd->bsd', h, w2) + b2
    x = A_q
    mod = (_silu(c) @ w_mod).reshape(c.shape[0], 6, 1, -1)
    sa, ca, ga, sb, cb, gb = (mod[:, 0].clone(), mod[:, 1].clone(), mod[:, 2].clone(), mod[:, 3].clone(), mod[:, 4].clone(), mod[:, 5].clone())
    h = _layernorm(x, axis=-1) * (1 + ca) + sa
    x = x + ga * _A_ref(h, A_k, A_v, A_shift_k, A_ssm_k, A_ssm_D)
    h = _layernorm(x, axis=-1) * (1 + cb) + sb
    x = x + gb * _B_ref(h, B_w1, B_b1, B_w2, B_b2)
    return x
```

```asm
; @launch grid=(256,1,1) block=(512,1,1) lds=163840
.amdgcn_target "amdgcn-amd-amdhsa--gfx950"
.text
.globl adaLN_cond__ssm_conv_h3__mixer_channel_mlp__prompt_kernel
.p2align 8
.type adaLN_cond__ssm_conv_h3__mixer_channel_mlp__prompt_kernel,@function
adaLN_cond__ssm_conv_h3__mixer_channel_mlp__prompt_kernel:
    s_load_dwordx2 s[40:41], s[0:1], 8
    s_load_dwordx2 s[44:45], s[0:1], 16
    s_load_dwordx16 s[4:19], s[0:1], 0
    s_load_dwordx16 s[20:35], s[0:1], 64
    s_cmp_ge_u32 s2, 256
    s_cbranch_scc1 L_exit
    v_lshrrev_b32 v1, 6, v0
    v_and_b32 v2, 63, v0
    s_and_b32 s54, s2, 15
    s_lshr_b32 s55, s2, 4
    v_readfirstlane_b32 s52, v1
    v_lshrrev_b32 v3, 3, v2
    v_bfe_u32 v4, v2, 4, 1
    v_and_b32 v5, 7, v2
    v_xor_b32 v4, v4, v5
    v_lshlrev_b32 v4, 4, v4
    v_lshl_add_u32 v4, v3, 11, v4
    s_lshl_b32 s3, s55, 18
    s_lshl_b32 s57, s54, 7
    s_add_u32 s3, s3, s57
    s_lshl_b32 s57, s52, 15
    s_add_u32 s57, s57, s3
    s_and_b32 s58, s52, 1
    s_lshl_b32 s58, s58, 6
    v_xor_b32 v5, s58, v4
    v_add_u32 v5, s57, v5
    v_xor_b32 v6, 32, v5
    s_movk_i32 s58, 15360
    v_add_u32 v16, s58, v6
    v_xor_b32 v17, 64, v5
    v_add_u32 v17, s58, v17
    s_mov_b32 s42, 4194304
    s_mov_b32 s43, 0x20000
    s_mov_b32 s46, s42
    s_mov_b32 s47, s43
    s_lshl_b32 s59, s52, 11
    s_add_u32 m0, s59, 87040
    s_waitcnt lgkmcnt(0)
    buffer_load_dwordx4 v6, s[40:43], 0 offen nt lds
    buffer_load_dwordx4 v17, s[40:43], 0 offen offset:1024 nt lds
    s_add_u32 m0, s59, 103424
    s_nop 0
    buffer_load_dwordx4 v5, s[44:47], 0 offen nt lds
    buffer_load_dwordx4 v16, s[44:47], 0 offen offset:1024 nt lds
    s_cmp_lg_u32 s52, 0
    s_cbranch_scc1 L_nohalo
    s_sub_u32 s3, s3, 16384
    s_cmp_eq_u32 s55, 0
    s_cselect_b32 s3, 0x80000000, s3
    v_add_u32 v7, s3, v4
    s_mov_b32 m0, 86016
    s_nop 0
    buffer_load_dwordx4 v7, s[40:43], 0 offen nt lds
L_nohalo:
    v_and_b32 v8, 15, v2
    v_lshrrev_b32 v9, 4, v2
    v_lshlrev_b32 v11, 4, v2
    v_and_b32 v10, 1, v9
    v_and_b32 v14, 3, v2
    v_lshl_add_u32 v10, v10, 2, v14
    v_lshlrev_b32 v10, 3, v10
    s_mov_b32 s48, s10
    s_mov_b32 s49, s11
    s_mov_b32 s50, 8192
    s_mov_b32 s51, 0x20000
    s_lshl_b32 s3, s52, 6
    s_lshl_b32 s57, s54, 9
    s_add_u32 s3, s3, s57
    buffer_load_dwordx2 v[12:13], v10, s[48:51], s3 offen
    s_and_b32 s57, s2, 7
    s_lshr_b32 s58, s2, 3
    s_and_b32 s60, s57, 1
    s_lshl_b32 s60, s60, 3
    s_and_b32 s3, s58, 7
    s_add_u32 s60, s60, s3
    s_lshr_b32 s61, s57, 1
    s_lshl_b32 s61, s61, 2
    s_lshr_b32 s3, s58, 3
    s_add_u32 s61, s61, s3
    s_mul_i32 s62, s61, 448
    s_and_b32 s3, s61, 1
    s_cmp_eq_u32 s3, 0
    s_cselect_b32 s63, 384, 0
    s_cselect_b32 s3, 0, 64
    s_add_u32 s63, s63, s62
    s_add_u32 s62, s62, s3
    s_lshl_b32 s1, s60, 4
    s_add_u32 s1, s1, s61
    s_lshl_b32 s0, s54, 4
    s_add_u32 s0, s0, s55
    s_lshl_b32 s59, s54, 7
    s_cmp_lt_u32 s52, 4
    s_movk_i32 s58, 20480
    s_cselect_b32 s58, 4096, s58
    s_add_u32 s59, s59, s58
    s_lshl_b32 s60, s0, 2
    s_add_u32 s60, s60, s52
    s_and_b32 s60, s60, 1023
    s_lshl_b32 s63, s60, 1
    s_and_b32 s63, s63, 0x7fc
    s_load_dword s53, s[34:35], 0
    s_load_dword s56, s[34:35], s59
    s_load_dword s33, s[14:15], s63
    v_lshlrev_b32 v14, 2, v2
    v_add_u32 v14, 162816, v14
    v_mov_b32 v15, 0
    ds_write_b32 v14, v15
    s_mov_b32 s36, s34
    s_mov_b32 s37, s35
    s_mov_b32 s38, 67108864
    s_mov_b32 s39, 0x20000
    s_mul_i32 s61, s52, 16640
    s_lshl_b32 s62, s60, 12
    s_mov_b32 s40, s12
    s_mov_b32 s41, s13
    s_mov_b32 s42, 4194304
    s_mov_b32 s43, 0x20000
    s_mov_b32 s44, s26
    s_mov_b32 s45, s27
    s_mov_b32 s46, 2048
    s_mov_b32 s47, 0x20000
    s_getpc_b64 s[64:65]
L_pc:
    s_lshr_b32 s3, s2, 3
    s_and_b32 s3, s3, 31
    s_lshl_b32 s3, s3, 10
    v_and_b32 v14, 7, v2
    v_lshlrev_b32 v14, 7, v14
    v_add_u32 v14, s3, v14
    v_min_u32 v14, L_end-L_pc-4, v14
    v_lshlrev_b32 v15, 2, v2
    s_and_b32 s3, s55, 7
    s_lshl_b32 s3, s3, 8
    s_add_u32 m0, s61, 32
    s_barrier
    s_cmp_ge_u32 s52, 4
    s_cbranch_scc1 L_b0
    s_sleep 12
    buffer_load_dwordx4 v11, s[40:43], s62 offen offset:0 nt lds
    buffer_load_dwordx4 v11, s[40:43], s62 offen offset:1024 nt lds
    buffer_load_dwordx4 v11, s[40:43], s62 offen offset:2048 nt lds
    buffer_load_dwordx4 v11, s[40:43], s62 offen offset:3072 nt lds
    s_branch L_c0
L_b0:
    buffer_load_dword v220, v15, s[44:47], s3 offen
    global_load_dword v221, v14, s[64:65]
    s_lshr_b32 s3, s55, 1
    s_lshl_b32 s3, s3, 7
    v_and_b32 v223, 1, v9
    v_subrev_u32 v14, 1, v223
    v_and_b32 v14, s3, v14
    v_lshl_add_u32 v14, v8, 10, v14
    s_lshl_b32 s3, s54, 14
    s_add_u32 s3, s3, 786432
    v_lshlrev_b32 v223, 14, v223
    v_lshl_add_u32 v223, v8, 7, v223
    s_movk_i32 s57, 12288
    s_cmp_eq_u32 s52, 7
    s_cselect_b32 exec_lo, -1, 1
    s_mov_b32 exec_hi, 0
    buffer_load_dword v221, v14, s[36:39], s3 offen sc1
    buffer_load_dword v221, v223, s[36:39], s57 offen sc1
    s_mov_b64 exec, -1
L_c0:
    v_bfe_u32 v16, v2, 2, 2
    v_and_b32 v17, 3, v2
    v_lshrrev_b32 v18, 1, v16
    v_xor_b32 v18, s52, v18
    v_lshrrev_b32 v19, 1, v9
    v_lshl_add_u32 v20, v19, 3, v17
    v_lshlrev_b32 v20, 10, v20
    v_lshl_add_u32 v20, v16, 7, v20
    v_and_b32 v21, 1, v9
    v_lshl_add_u32 v20, v21, 3, v20
    v_add_u32 v20, 86016, v20
    v_lshlrev_b32 v22, 1, v17
    v_xor_b32 v22, v22, v18
    v_lshl_add_u32 v22, v22, 4, v20
    v_add_u32 v23, 1, v17
    v_and_b32 v23, 3, v23
    v_lshlrev_b32 v23, 1, v23
    v_xor_b32 v23, v23, v18
    v_lshl_add_u32 v23, v23, 4, v20
    v_lshl_add_u32 v24, v19, 3, v16
    v_sub_u32 v24, 11, v24
    v_lshlrev_b32 v24, 6, v24
    v_lshl_add_u32 v24, v17, 4, v24
    v_lshl_add_u32 v24, v21, 14, v24
    s_lshl_b32 s3, s54, 18
    s_lshl_b32 s57, s52, 15
    s_add_u32 s3, s3, s57
    s_lshl_b32 s57, s55, 10
    s_sub_u32 s3, s3, s57
    s_add_u32 s58, s3, 1063936
    s_waitcnt vmcnt(4)
    v_lshlrev_b32 v26, 16, v12
    v_and_b32 v27, 0xffff0000, v12
    v_lshlrev_b32 v28, 16, v13
    v_and_b32 v29, 0xffff0000, v13
    s_waitcnt lgkmcnt(0)
    s_mul_i32 s53, s53, 0x9E3779B1
    s_add_u32 s53, s53, 0x7F4A7C15
    s_lshl_b32 s59, s0, 3
    s_add_u32 s59, s59, s52
    s_lshl_b32 s59, s59, 7
    s_add_u32 s59, s59, 786432
    s_barrier
    ds_read_b64_tr_b16 v[32:33], v22 offset:512
    ds_read_b64_tr_b16 v[34:35], v23 offset:1024
    ds_read_b64_tr_b16 v[36:37], v23 offset:1536
    ds_read_b64_tr_b16 v[44:45], v22 offset:17408
    ds_read_b64_tr_b16 v[46:47], v22 offset:17920
    ds_read_b64_tr_b16 v[38:39], v22 offset:4608
    ds_read_b64_tr_b16 v[40:41], v23 offset:5120
    ds_read_b64_tr_b16 v[42:43], v23 offset:5632
    ds_read_b64_tr_b16 v[48:49], v22 offset:21504
    ds_read_b64_tr_b16 v[50:51], v22 offset:22016
    s_waitcnt lgkmcnt(7)
    v_and_b32 v52, 0xffff0000, v32
    v_lshlrev_b32 v53, 16, v33
    v_and_b32 v54, 0xffff0000, v33
    v_lshlrev_b32 v55, 16, v34
    v_and_b32 v56, 0xffff0000, v34
    v_lshlrev_b32 v57, 16, v35
    v_and_b32 v58, 0xffff0000, v35
    v_lshlrev_b32 v59, 16, v36
    v_and_b32 v60, 0xffff0000, v36
    v_lshlrev_b32 v61, 16, v37
    v_and_b32 v62, 0xffff0000, v37
    v_mul_f32 v64, v29, v52
    v_mul_f32 v65, v29, v53
    v_mul_f32 v66, v29, v54
    v_mul_f32 v67, v29, v55
    v_mul_f32 v68, v29, v56
    v_mul_f32 v69, v29, v57
    v_mul_f32 v70, v29, v58
    v_mul_f32 v71, v29, v59
    v_fmac_f32 v64, v28, v53
    v_fmac_f32 v65, v28, v54
    v_fmac_f32 v66, v28, v55
    v_fmac_f32 v67, v28, v56
    v_fmac_f32 v68, v28, v57
    v_fmac_f32 v69, v28, v58
    v_fmac_f32 v70, v28, v59
    v_fmac_f32 v71, v28, v60
    v_fmac_f32 v64, v27, v54
    v_fmac_f32 v65, v27, v55
    v_fmac_f32 v66, v27, v56
    v_fmac_f32 v67, v27, v57
    v_fmac_f32 v68, v27, v58
    v_fmac_f32 v69, v27, v59
    v_fmac_f32 v70, v27, v60
    v_fmac_f32 v71, v27, v61
    v_fmac_f32 v64, v26, v55
    v_fmac_f32 v65, v26, v56
    v_fmac_f32 v66, v26, v57
    v_fmac_f32 v67, v26, v58
    v_fmac_f32 v68, v26, v59
    v_fmac_f32 v69, v26, v60
    v_fmac_f32 v70, v26, v61
    v_fmac_f32 v71, v26, v62
    s_waitcnt lgkmcnt(5)
    v_lshlrev_b32 v52, 16, v44
    v_and_b32 v53, 0xffff0000, v44
    v_lshlrev_b32 v54, 16, v45
    v_and_b32 v55, 0xffff0000, v45
    v_lshlrev_b32 v56, 16, v46
    v_and_b32 v57, 0xffff0000, v46
    v_lshlrev_b32 v58, 16, v47
    v_and_b32 v59, 0xffff0000, v47
    v_mul_f32 v64, v64, v52
    v_mul_f32 v65, v65, v53
    v_mul_f32 v66, v66, v54
    v_mul_f32 v67, v67, v55
    v_mul_f32 v68, v68, v56
    v_mul_f32 v69, v69, v57
    v_mul_f32 v70, v70, v58
    v_mul_f32 v71, v71, v59
    v_cvt_pk_bf16_f32 v72, v71, v70
    v_cvt_pk_bf16_f32 v73, v69, v68
    v_cvt_pk_bf16_f32 v74, v67, v66
    v_cvt_pk_bf16_f32 v75, v65, v64
    buffer_store_dwordx4 v[72:75], v24, s[36:39], s58 offen offset:256 sc1
    s_waitcnt lgkmcnt(2)
    v_and_b32 v52, 0xffff0000, v38
    v_lshlrev_b32 v53, 16, v39
    v_and_b32 v54, 0xffff0000, v39
    v_lshlrev_b32 v55, 16, v40
    v_and_b32 v56, 0xffff0000, v40
    v_lshlrev_b32 v57, 16, v41
    v_and_b32 v58, 0xffff0000, v41
    v_lshlrev_b32 v59, 16, v42
    v_and_b32 v60, 0xffff0000, v42
    v_lshlrev_b32 v61, 16, v43
    v_and_b32 v62, 0xffff0000, v43
    v_mul_f32 v64, v29, v52
    v_mul_f32 v65, v29, v53
    v_mul_f32 v66, v29, v54
    v_mul_f32 v67, v29, v55
    v_mul_f32 v68, v29, v56
    v_mul_f32 v69, v29, v57
    v_mul_f32 v70, v29, v58
    v_mul_f32 v71, v29, v59
    v_fmac_f32 v64, v28, v53
    v_fmac_f32 v65, v28, v54
    v_fmac_f32 v66, v28, v55
    v_fmac_f32 v67, v28, v56
    v_fmac_f32 v68, v28, v57
    v_fmac_f32 v69, v28, v58
    v_fmac_f32 v70, v28, v59
    v_fmac_f32 v71, v28, v60
    v_fmac_f32 v64, v27, v54
    v_fmac_f32 v65, v27, v55
    v_fmac_f32 v66, v27, v56
    v_fmac_f32 v67, v27, v57
    v_fmac_f32 v68, v27, v58
    v_fmac_f32 v69, v27, v59
    v_fmac_f32 v70, v27, v60
    v_fmac_f32 v71, v27, v61
    v_fmac_f32 v64, v26, v55
    v_fmac_f32 v65, v26, v56
    v_fmac_f32 v66, v26, v57
    v_fmac_f32 v67, v26, v58
    v_fmac_f32 v68, v26, v59
    v_fmac_f32 v69, v26, v60
    v_fmac_f32 v70, v26, v61
    v_fmac_f32 v71, v26, v62
    s_waitcnt lgkmcnt(0)
    v_lshlrev_b32 v52, 16, v48
    v_and_b32 v53, 0xffff0000, v48
    v_lshlrev_b32 v54, 16, v49
    v_and_b32 v55, 0xffff0000, v49
    v_lshlrev_b32 v56, 16, v50
    v_and_b32 v57, 0xffff0000, v50
    v_lshlrev_b32 v58, 16, v51
    v_and_b32 v59, 0xffff0000, v51
    v_mul_f32 v64, v64, v52
    v_mul_f32 v65, v65, v53
    v_mul_f32 v66, v66, v54
    v_mul_f32 v67, v67, v55
    v_mul_f32 v68, v68, v56
    v_mul_f32 v69, v69, v57
    v_mul_f32 v70, v70, v58
    v_mul_f32 v71, v71, v59
    v_cvt_pk_bf16_f32 v76, v71, v70
    v_cvt_pk_bf16_f32 v77, v69, v68
    v_cvt_pk_bf16_f32 v78, v67, v66
    v_cvt_pk_bf16_f32 v79, v65, v64
    buffer_store_dwordx4 v[76:79], v24, s[36:39], s58 offen offset:0 sc1
    s_and_b32 s3, s55, 7
    s_or_b32 s3, s3, s52
    s_cmp_lg_u32 s3, 0
    s_cbranch_scc1 L_nozero
    s_lshr_b32 s3, s0, 3
    s_mul_i32 s3, s3, 768
    s_add_u32 s3, s3, 65536
    v_mov_b32 v48, 0
    v_mov_b32 v49, 0
    v_mov_b32 v50, 0
    v_mov_b32 v51, 0
    s_mov_b32 exec_lo, -1
    s_mov_b32 exec_hi, 0xffff
    buffer_store_dwordx4 v[48:51], v11, s[36:39], s3 offen sc1
    s_mov_b64 exec, -1
L_nozero:
    s_waitcnt vmcnt(0)
L_ssmd:
    v_mov_b32 v52, s53
    v_mov_b32 v53, s53
    v_mov_b32 v54, s53
    v_mov_b32 v55, s53
    s_mov_b64 exec, 0xff
    buffer_store_dwordx4 v[52:55], v11, s[36:39], s59 offen sc1
    s_mov_b64 exec, -1
    s_cmp_ge_u32 s52, 4
    s_cbranch_scc1 L_b1
    s_waitcnt vmcnt(1)
    v_add_u32 v41, s61, v11
    ds_read_b128 v[192:195], v41 offset:32
    ds_read_b64 v[208:209], v41 offset:48
    ds_read_b128 v[196:199], v41 offset:1056
    ds_read_b64 v[210:211], v41 offset:1072
    ds_read_b128 v[200:203], v41 offset:2080
    ds_read_b64 v[212:213], v41 offset:2096
    ds_read_b128 v[204:207], v41 offset:3104
    ds_read_b64 v[214:215], v41 offset:3120
    v_add_u32 v42, v9, v8
    v_lshlrev_b32 v40, 1, v42
    v_add_u32 v40, s61, v40
    ds_read_u16 v216, v40
    v_cmp_lt_u32 vcc, 15, v42
    v_mul_u32_u24 v40, 4160, v9
    v_lshl_add_u32 v40, v8, 1, v40
    v_add_u32 v40, s61, v40
    v_mov_b32 v14, 0
    v_mov_b32 v15, 0
    v_lshlrev_b32 v13, 3, v0
    v_add_u32 v13, 82944, v13
    s_waitcnt lgkmcnt(0)
    v_alignbit_b32 v112, v193, v192, 16
    v_alignbit_b32 v113, v194, v193, 16
    v_alignbit_b32 v114, v195, v194, 16
    v_alignbit_b32 v115, v208, v195, 16
    ds_write_b128 v41, v[112:115] offset:4192
    v_mov_b32 v116, v193
    v_mov_b32 v117, v194
    v_mov_b32 v118, v195
    v_mov_b32 v119, v208
    ds_write_b128 v41, v[116:119] offset:8352
    v_alignbit_b32 v120, v194, v193, 16
    v_alignbit_b32 v121, v195, v194, 16
    v_alignbit_b32 v122, v208, v195, 16
    v_alignbit_b32 v123, v209, v208, 16
    ds_write_b128 v41, v[120:123] offset:12512
    v_alignbit_b32 v124, v197, v196, 16
    v_alignbit_b32 v125, v198, v197, 16
    v_alignbit_b32 v126, v199, v198, 16
    v_alignbit_b32 v127, v210, v199, 16
    ds_write_b128 v41, v[124:127] offset:5216
    v_mov_b32 v128, v197
    v_mov_b32 v129, v198
    v_mov_b32 v130, v199
    v_mov_b32 v131, v210
    ds_write_b128 v41, v[128:131] offset:9376
    v_alignbit_b32 v132, v198, v197, 16
    v_alignbit_b32 v133, v199, v198, 16
    v_alignbit_b32 v134, v210, v199, 16
    v_alignbit_b32 v135, v211, v210, 16
    ds_write_b128 v41, v[132:135] offset:13536
    v_alignbit_b32 v136, v201, v200, 16
    v_alignbit_b32 v137, v202, v201, 16
    v_alignbit_b32 v138, v203, v202, 16
    v_alignbit_b32 v139, v212, v203, 16
    ds_write_b128 v41, v[136:139] offset:6240
    v_mov_b32 v140, v201
    v_mov_b32 v141, v202
    v_mov_b32 v142, v203
    v_mov_b32 v143, v212
    ds_write_b128 v41, v[140:143] offset:10400
    v_alignbit_b32 v144, v202, v201, 16
    v_alignbit_b32 v145, v203, v202, 16
    v_alignbit_b32 v146, v212, v203, 16
    v_alignbit_b32 v147, v213, v212, 16
    ds_write_b128 v41, v[144:147] offset:14560
    v_alignbit_b32 v148, v205, v204, 16
    v_alignbit_b32 v149, v206, v205, 16
    v_alignbit_b32 v150, v207, v206, 16
    v_alignbit_b32 v151, v214, v207, 16
    ds_write_b128 v41, v[148:151] offset:7264
    v_mov_b32 v152, v205
    v_mov_b32 v153, v206
    v_mov_b32 v154, v207
    v_mov_b32 v155, v214
    ds_write_b128 v41, v[152:155] offset:11424
    v_alignbit_b32 v156, v206, v205, 16
    v_alignbit_b32 v157, v207, v206, 16
    v_alignbit_b32 v158, v214, v207, 16
    v_alignbit_b32 v159, v215, v214, 16
    ds_write_b128 v41, v[156:159] offset:15584
    v_cndmask_b32 v216, 0, v216, vcc
    ds_write_b16 v40, v216
    ds_write_b64 v13, v[14:15]
    s_and_b32 s3, s60, 1
    s_lshl_b32 s3, s3, 4
    s_lshr_b32 s33, s33, s3
    s_and_b32 s33, s33, 0xffff
    v_lshl_add_u32 v48, v9, 3, v8
    v_sub_u32 v48, 15, v48
    v_and_b32 v49, 1, v48
    v_lshlrev_b32 v49, 4, v49
    v_lshlrev_b32 v49, v49, s33
    v_ashrrev_i32 v48, 1, v48
    v_cmp_eq_u32 vcc, 0, v48
    s_nop 1
    v_cndmask_b32 v64, 0, v49, vcc
    v_cmp_eq_u32 vcc, 1, v48
    s_nop 1
    v_cndmask_b32 v65, 0, v49, vcc
    v_cmp_eq_u32 vcc, 2, v48
    s_nop 1
    v_cndmask_b32 v66, 0, v49, vcc
    v_cmp_eq_u32 vcc, 3, v48
    s_nop 1
    v_cndmask_b32 v67, 0, v49, vcc
    v_add_u32 v42, 1, v8
    v_and_b32 v43, 3, v42
    v_mul_u32_u24 v43, 4160, v43
    v_lshrrev_b32 v42, 2, v42
    v_lshl_add_u32 v43, v42, 3, v43
    v_lshl_add_u32 v43, v9, 4, v43
    v_add_u32 v43, s61, v43
    v_lshlrev_b32 v48, 1, v8
    v_sub_u32 v48, 30, v48
    v_add_u32 v48, v48, v9
    v_lshrrev_b32 v49, 2, v48
    v_add_u32 v50, 0, v49
    v_and_b32 v50, 3, v50
    v_xor_b32 v50, s52, v50
    v_lshlrev_b32 v50, 4, v50
    v_lshl_add_u32 v50, v48, 6, v50
    v_add_u32 v44, 66560, v50
    v_add_u32 v50, 1, v49
    v_and_b32 v50, 3, v50
    v_xor_b32 v50, s52, v50
    v_lshlrev_b32 v50, 4, v50
    v_lshl_add_u32 v50, v48, 6, v50
    v_add_u32 v45, 66560, v50
    s_lshr_b32 s3, s52, 1
    v_lshl_add_u32 v46, v9, 1, s3
    v_and_b32 v48, 7, v8
    v_xor_b32 v46, v46, v48
    v_lshlrev_b32 v46, 4, v46
    v_lshl_add_u32 v46, v8, 7, v46
    s_and_b32 s3, s52, 1
    s_lshl_b32 s3, s3, 3
    s_add_u32 s3, s3, 86016
    v_add_u32 v46, s3, v46
    s_waitcnt lgkmcnt(0)
    ds_read_b64 v[112:113], v43 offset:0
    ds_read_b64 v[114:115], v43 offset:8
    ds_read_b64 v[116:117], v43 offset:512
    ds_read_b64 v[118:119], v43 offset:520
    ds_read_b64 v[120:121], v43 offset:1024
    ds_read_b64 v[122:123], v43 offset:1032
    ds_read_b64 v[124:125], v43 offset:1536
    ds_read_b64 v[126:127], v43 offset:1544
    ds_read_b64 v[128:129], v43 offset:2048
    ds_read_b64 v[130:131], v43 offset:2056
    ds_read_b64 v[132:133], v43 offset:2560
    ds_read_b64 v[134:135], v43 offset:2568
    ds_read_b64 v[136:137], v43 offset:3072
    ds_read_b64 v[138:139], v43 offset:3080
    ds_read_b64 v[140:141], v43 offset:3584
    ds_read_b64 v[142:143], v43 offset:3592
    s_mov_b32 s48, s4
    s_mov_b32 s49, s5
    s_mov_b32 s50, 4194304
    s_mov_b32 s51, 0x20000
    v_lshrrev_b32 v48, 3, v0
    v_and_b32 v49, 3, v0
    v_lshl_add_u32 v48, v48, 2, v49
    v_bfe_u32 v49, v0, 2, 1
    v_lshlrev_b32 v48, 3, v48
    v_lshl_add_u32 v48, v49, 13, v48
    s_lshl_b32 s3, s1, 14
    v_add_u32 v48, s3, v48
    v_add_u32 v49, 4096, v48
    s_mov_b32 s59, 3
    s_waitcnt lgkmcnt(0)
    s_barrier
    ds_read_b128 v[144:147], v44 offset:14336
    ds_read_b128 v[148:151], v44 offset:12288
    ds_read_b128 v[152:155], v44 offset:10240
    ds_read_b128 v[156:159], v44 offset:8192
    ds_read_b128 v[160:163], v44 offset:6144
    ds_read_b128 v[164:167], v44 offset:4096
    ds_read_b128 v[168:171], v44 offset:2048
    ds_read_b128 v[172:175], v44 offset:0
    buffer_load_dwordx2 v[240:241], v48, s[48:51], 0 offen offset:0 nt
    buffer_load_dwordx2 v[242:243], v48, s[48:51], 0 offen offset:2048 nt
    buffer_load_dwordx2 v[244:245], v49, s[48:51], 0 offen offset:0 nt
    buffer_load_dwordx2 v[246:247], v49, s[48:51], 0 offen offset:2048 nt
    s_waitcnt lgkmcnt(7)
    v_mfma_f32_16x16x32_bf16 v[80:83], v[64:67], v[144:147], 0
    s_waitcnt lgkmcnt(6)
    v_mfma_f32_16x16x32_bf16 v[84:87], v[64:67], v[148:151], 0
    s_waitcnt lgkmcnt(5)
    v_mfma_f32_16x16x32_bf16 v[88:91], v[64:67], v[152:155], 0
    s_waitcnt lgkmcnt(4)
    v_mfma_f32_16x16x32_bf16 v[92:95], v[64:67], v[156:159], 0
    s_waitcnt lgkmcnt(3)
    v_mfma_f32_16x16x32_bf16 v[96:99], v[64:67], v[160:163], 0
    s_waitcnt lgkmcnt(2)
    v_mfma_f32_16x16x32_bf16 v[100:103], v[64:67], v[164:167], 0
    s_waitcnt lgkmcnt(1)
    v_mfma_f32_16x16x32_bf16 v[104:107], v[64:67], v[168:171], 0
    s_waitcnt lgkmcnt(0)
    v_mfma_f32_16x16x32_bf16 v[108:111], v[64:67], v[172:175], 0
.p2align 3
L_conv:
    v_mfma_f32_16x16x32_bf16 v[80:83], v[112:115], v[144:147], v[80:83]
    ds_read_b128 v[208:211], v45 offset:14592
    v_mfma_f32_16x16x32_bf16 v[84:87], v[112:115], v[148:151], v[84:87]
    ds_read_b128 v[212:215], v45 offset:12544
    v_mfma_f32_16x16x32_bf16 v[88:91], v[112:115], v[152:155], v[88:91]
    ds_read_b128 v[216:219], v45 offset:10496
    v_mfma_f32_16x16x32_bf16 v[92:95], v[112:115], v[156:159], v[92:95]
    ds_read_b128 v[220:223], v45 offset:8448
    v_mfma_f32_16x16x32_bf16 v[96:99], v[112:115], v[160:163], v[96:99]
    ds_read_b128 v[224:227], v45 offset:6400
    v_mfma_f32_16x16x32_bf16 v[100:103], v[112:115], v[164:167], v[100:103]
    ds_read_b128 v[228:231], v45 offset:4352
    v_mfma_f32_16x16x32_bf16 v[104:107], v[112:115], v[168:171], v[104:107]
    ds_read_b128 v[232:235], v45 offset:2304
    v_mfma_f32_16x16x32_bf16 v[108:111], v[112:115], v[172:175], v[108:111]
    ds_read_b128 v[236:239], v45 offset:256
    v_mfma_f32_16x16x32_bf16 v[84:87], v[116:119], v[144:147], v[84:87]
    ds_read_b64 v[176:177], v43 offset:64
    v_mfma_f32_16x16x32_bf16 v[88:91], v[116:119], v[148:151], v[88:91]
    ds_read_b64 v[178:179], v43 offset:72
    v_mfma_f32_16x16x32_bf16 v[92:95], v[116:119], v[152:155], v[92:95]
    ds_read_b64 v[180:181], v43 offset:576
    v_mfma_f32_16x16x32_bf16 v[96:99], v[116:119], v[156:159], v[96:99]
    ds_read_b64 v[182:183], v43 offset:584
    v_mfma_f32_16x16x32_bf16 v[100:103], v[116:119], v[160:163], v[100:103]
    ds_read_b64 v[184:185], v43 offset:1088
    v_mfma_f32_16x16x32_bf16 v[104:107], v[116:119], v[164:167], v[104:107]
    ds_read_b64 v[186:187], v43 offset:1096
    v_mfma_f32_16x16x32_bf16 v[108:111], v[116:119], v[168:171], v[108:111]
    ds_read_b64 v[188:189], v43 offset:1600
    v_mfma_f32_16x16x32_bf16 v[88:91], v[120:123], v[144:147], v[88:91]
    ds_read_b64 v[190:191], v43 offset:1608
    v_mfma_f32_16x16x32_bf16 v[92:95], v[120:123], v[148:151], v[92:95]
    ds_read_b64 v[192:193], v43 offset:2112
    v_mfma_f32_16x16x32_bf16 v[96:99], v[120:123], v[152:155], v[96:99]
    ds_read_b64 v[194:195], v43 offset:2120
    v_mfma_f32_16x16x32_bf16 v[100:103], v[120:123], v[156:159], v[100:103]
    ds_read_b64 v[196:197], v43 offset:2624
    v_mfma_f32_16x16x32_bf16 v[104:107], v[120:123], v[160:163], v[104:107]
    ds_read_b64 v[198:199], v43 offset:2632
    v_mfma_f32_16x16x32_bf16 v[108:111], v[120:123], v[164:167], v[108:111]
    ds_read_b64 v[200:201], v43 offset:3136
    v_mfma_f32_16x16x32_bf16 v[92:95], v[124:127], v[144:147], v[92:95]
    ds_read_b64 v[202:203], v43 offset:3144
    v_mfma_f32_16x16x32_bf16 v[96:99], v[124:127], v[148:151], v[96:99]
    ds_read_b64 v[204:205], v43 offset:3648
    v_mfma_f32_16x16x32_bf16 v[100:103], v[124:127], v[152:155], v[100:103]
    ds_read_b64 v[206:207], v43 offset:3656
    v_mfma_f32_16x16x32_bf16 v[104:107], v[124:127], v[156:159], v[104:107]
    v_xor_b32 v44, 32, v44
    v_xor_b32 v45, 32, v45
    v_mfma_f32_16x16x32_bf16 v[108:111], v[124:127], v[160:163], v[108:111]
    v_add_u32 v44, 512, v44
    v_mfma_f32_16x16x32_bf16 v[96:99], v[128:131], v[144:147], v[96:99]
    v_add_u32 v45, 512, v45
    v_mfma_f32_16x16x32_bf16 v[100:103], v[128:131], v[148:151], v[100:103]
    v_add_u32 v43, 128, v43
    v_mfma_f32_16x16x32_bf16 v[104:107], v[128:131], v[152:155], v[104:107]
    v_mfma_f32_16x16x32_bf16 v[108:111], v[128:131], v[156:159], v[108:111]
    v_mfma_f32_16x16x32_bf16 v[100:103], v[132:135], v[144:147], v[100:103]
    v_mfma_f32_16x16x32_bf16 v[104:107], v[132:135], v[148:151], v[104:107]
    v_mfma_f32_16x16x32_bf16 v[108:111], v[132:135], v[152:155], v[108:111]
    v_mfma_f32_16x16x32_bf16 v[104:107], v[136:139], v[144:147], v[104:107]
    v_mfma_f32_16x16x32_bf16 v[108:111], v[136:139], v[148:151], v[108:111]
    s_waitcnt lgkmcnt(0)
    s_nop 0
    v_mfma_f32_16x16x32_bf16 v[108:111], v[140:143], v[144:147], v[108:111]
    v_mfma_f32_16x16x32_bf16 v[80:83], v[176:179], v[208:211], v[80:83]
    ds_read_b128 v[144:147], v44 offset:14336
    v_mfma_f32_16x16x32_bf16 v[84:87], v[176:179], v[212:215], v[84:87]
    ds_read_b128 v[148:151], v44 offset:12288
    v_mfma_f32_16x16x32_bf16 v[88:91], v[176:179], v[216:219], v[88:91]
    ds_read_b128 v[152:155], v44 offset:10240
    v_mfma_f32_16x16x32_bf16 v[92:95], v[176:179], v[220:223], v[92:95]
    ds_read_b128 v[156:159], v44 offset:8192
    v_mfma_f32_16x16x32_bf16 v[96:99], v[176:179], v[224:227], v[96:99]
    ds_read_b128 v[160:163], v44 offset:6144
    v_mfma_f32_16x16x32_bf16 v[100:103], v[176:179], v[228:231], v[100:103]
    ds_read_b128 v[164:167], v44 offset:4096
    v_mfma_f32_16x16x32_bf16 v[104:107], v[176:179], v[232:235], v[104:107]
    ds_read_b128 v[168:171], v44 offset:2048
    v_mfma_f32_16x16x32_bf16 v[108:111], v[176:179], v[236:239], v[108:111]
    ds_read_b128 v[172:175], v44 offset:0
    v_mfma_f32_16x16x32_bf16 v[84:87], v[180:183], v[208:211], v[84:87]
    ds_read_b64 v[112:113], v43 offset:0
    v_mfma_f32_16x16x32_bf16 v[88:91], v[180:183], v[212:215], v[88:91]
    ds_read_b64 v[114:115], v43 offset:8
    v_mfma_f32_16x16x32_bf16 v[92:95], v[180:183], v[216:219], v[92:95]
    ds_read_b64 v[116:117], v43 offset:512
    v_mfma_f32_16x16x32_bf16 v[96:99], v[180:183], v[220:223], v[96:99]
    ds_read_b64 v[118:119], v43 offset:520
    v_mfma_f32_16x16x32_bf16 v[100:103], v[180:183], v[224:227], v[100:103]
    ds_read_b64 v[120:121], v43 offset:1024
    v_mfma_f32_16x16x32_bf16 v[104:107], v[180:183], v[228:231], v[104:107]
    ds_read_b64 v[122:123], v43 offset:1032
    v_mfma_f32_16x16x32_bf16 v[108:111], v[180:183], v[232:235], v[108:111]
    ds_read_b64 v[124:125], v43 offset:1536
    v_mfma_f32_16x16x32_bf16 v[88:91], v[184:187], v[208:211], v[88:91]
    ds_read_b64 v[126:127], v43 offset:1544
    v_mfma_f32_16x16x32_bf16 v[92:95], v[184:187], v[212:215], v[92:95]
    ds_read_b64 v[128:129], v43 offset:2048
    v_mfma_f32_16x16x32_bf16 v[96:99], v[184:187], v[216:219], v[96:99]
    ds_read_b64 v[130:131], v43 offset:2056
    v_mfma_f32_16x16x32_bf16 v[100:103], v[184:187], v[220:223], v[100:103]
    ds_read_b64 v[132:133], v43 offset:2560
    v_mfma_f32_16x16x32_bf16 v[104:107], v[184:187], v[224:227], v[104:107]
    ds_read_b64 v[134:135], v43 offset:2568
    v_mfma_f32_16x16x32_bf16 v[108:111], v[184:187], v[228:231], v[108:111]
    ds_read_b64 v[136:137], v43 offset:3072
    v_mfma_f32_16x16x32_bf16 v[92:95], v[188:191], v[208:211], v[92:95]
    ds_read_b64 v[138:139], v43 offset:3080
    v_mfma_f32_16x16x32_bf16 v[96:99], v[188:191], v[212:215], v[96:99]
    ds_read_b64 v[140:141], v43 offset:3584
    v_mfma_f32_16x16x32_bf16 v[100:103], v[188:191], v[216:219], v[100:103]
    ds_read_b64 v[142:143], v43 offset:3592
    v_mfma_f32_16x16x32_bf16 v[104:107], v[188:191], v[220:223], v[104:107]
    s_sub_u32 s59, s59, 1
    s_nop 0
    v_mfma_f32_16x16x32_bf16 v[108:111], v[188:191], v[224:227], v[108:111]
    v_mfma_f32_16x16x32_bf16 v[96:99], v[192:195], v[208:211], v[96:99]
    v_mfma_f32_16x16x32_bf16 v[100:103], v[192:195], v[212:215], v[100:103]
    v_mfma_f32_16x16x32_bf16 v[104:107], v[192:195], v[216:219], v[104:107]
    v_mfma_f32_16x16x32_bf16 v[108:111], v[192:195], v[220:223], v[108:111]
    v_mfma_f32_16x16x32_bf16 v[100:103], v[196:199], v[208:211], v[100:103]
    v_mfma_f32_16x16x32_bf16 v[104:107], v[196:199], v[212:215], v[104:107]
    v_mfma_f32_16x16x32_bf16 v[108:111], v[196:199], v[216:219], v[108:111]
    v_mfma_f32_16x16x32_bf16 v[104:107], v[200:203], v[208:211], v[104:107]
    v_mfma_f32_16x16x32_bf16 v[108:111], v[200:203], v[212:215], v[108:111]
    s_waitcnt lgkmcnt(0)
    s_nop 0
    v_mfma_f32_16x16x32_bf16 v[108:111], v[204:207], v[208:211], v[108:111]
    s_cbranch_scc0 L_conv
    v_cvt_pk_bf16_f32 v64, v80, v81
    v_cvt_pk_bf16_f32 v65, v82, v83
    ds_write_b64 v46, v[64:65] offset:0
    v_cvt_pk_bf16_f32 v66, v84, v85
    v_cvt_pk_bf16_f32 v67, v86, v87
    ds_write_b64 v46, v[66:67] offset:2048
    v_cvt_pk_bf16_f32 v68, v88, v89
    v_cvt_pk_bf16_f32 v69, v90, v91
    ds_write_b64 v46, v[68:69] offset:4096
    v_cvt_pk_bf16_f32 v70, v92, v93
    v_cvt_pk_bf16_f32 v71, v94, v95
    ds_write_b64 v46, v[70:71] offset:6144
    v_cvt_pk_bf16_f32 v72, v96, v97
    v_cvt_pk_bf16_f32 v73, v98, v99
    ds_write_b64 v46, v[72:73] offset:8192
    v_cvt_pk_bf16_f32 v74, v100, v101
    v_cvt_pk_bf16_f32 v75, v102, v103
    ds_write_b64 v46, v[74:75] offset:10240
    v_cvt_pk_bf16_f32 v76, v104, v105
    v_cvt_pk_bf16_f32 v77, v106, v107
    ds_write_b64 v46, v[76:77] offset:12288
    v_cvt_pk_bf16_f32 v78, v108, v109
    v_cvt_pk_bf16_f32 v79, v110, v111
    ds_write_b64 v46, v[78:79] offset:14336
    v_mov_b32 v52, 163008
    v_mov_b32 v53, 1
    s_waitcnt lgkmcnt(0)
    s_mov_b64 exec, 1
    ds_add_u32 v52, v53
    s_mov_b64 exec, -1
    v_lshrrev_b32 v48, 3, v2
    v_and_b32 v49, 7, v2
    v_xor_b32 v50, v48, v49
    v_lshlrev_b32 v50, 4, v50
    v_lshl_add_u32 v50, v48, 7, v50
    s_lshl_b32 s3, s52, 12
    s_add_u32 s3, s3, 86016
    v_add_u32 v50, s3, v50
    v_lshrrev_b32 v51, 2, v49
    v_lshl_add_u32 v51, v48, 1, v51
    v_lshlrev_b32 v51, 14, v51
    v_and_b32 v49, 3, v49
    v_lshl_add_u32 v51, v49, 4, v51
    s_lshl_b32 s3, s52, 20
    s_lshl_b32 s57, s0, 6
    s_add_u32 s3, s3, s57
    s_add_u32 s3, s3, 5242880
L_rv:
    ds_read_b32 v53, v52
    s_waitcnt lgkmcnt(0)
    v_readfirstlane_b32 s57, v53
    s_nop 0
    s_cmp_lt_u32 s57, 4
    s_cbranch_scc1 L_rv
    ds_read_b128 v[64:67], v50 offset:0
    ds_read_b128 v[68:71], v50 offset:1024
    ds_read_b128 v[72:75], v50 offset:2048
    ds_read_b128 v[76:79], v50 offset:3072
    s_waitcnt lgkmcnt(3)
    buffer_store_dwordx4 v[64:67], v51, s[36:39], s3 offen sc1
    s_add_u32 s3, s3, 262144
    s_waitcnt lgkmcnt(2)
    buffer_store_dwordx4 v[68:71], v51, s[36:39], s3 offen sc1
    s_add_u32 s3, s3, 262144
    s_waitcnt lgkmcnt(1)
    buffer_store_dwordx4 v[72:75], v51, s[36:39], s3 offen sc1
    s_add_u32 s3, s3, 262144
    s_waitcnt lgkmcnt(0)
    buffer_store_dwordx4 v[76:79], v51, s[36:39], s3 offen sc1
    s_waitcnt vmcnt(4)
    v_lshrrev_b32 v6, 3, v0
    v_and_b32 v7, 3, v0
    v_lshl_add_u32 v6, v6, 2, v7
    v_bfe_u32 v7, v0, 2, 1
    s_mov_b32 s8, 0x00110011
    s_mov_b32 s9, s8
    v_lshrrev_b32 v4, 4, v2
    v_lshlrev_b32 v4, 3, v4
    v_lshlrev_b32 v5, 5, v7
    v_add_u32 v5, 162816, v5
    v_add_u32 v4, v4, v5
    v_lshlrev_b32 v16, 16, v240
    v_and_b32 v20, 0xffff0000, v240
    v_lshlrev_b32 v24, 16, v241
    v_and_b32 v28, 0xffff0000, v241
    v_lshlrev_b32 v17, 16, v242
    v_and_b32 v21, 0xffff0000, v242
    v_lshlrev_b32 v25, 16, v243
    v_and_b32 v29, 0xffff0000, v243
    v_lshlrev_b32 v18, 16, v244
    v_and_b32 v22, 0xffff0000, v244
    v_lshlrev_b32 v26, 16, v245
    v_and_b32 v30, 0xffff0000, v245
    v_lshlrev_b32 v19, 16, v246
    v_and_b32 v23, 0xffff0000, v246
    v_lshlrev_b32 v27, 16, v247
    v_and_b32 v31, 0xffff0000, v247
    v_pk_add_f32 v[32:33], v[16:17], v[20:21]
    v_pk_add_f32 v[34:35], v[18:19], v[22:23]
    v_pk_mul_f32 v[36:37], v[16:17], v[16:17]
    v_pk_mul_f32 v[38:39], v[18:19], v[18:19]
    v_pk_fma_f32 v[36:37], v[20:21], v[20:21], v[36:37]
    v_pk_fma_f32 v[38:39], v[22:23], v[22:23], v[38:39]
    v_pk_add_f32 v[32:33], v[32:33], v[24:25]
    v_pk_add_f32 v[34:35], v[34:35], v[26:27]
    v_pk_fma_f32 v[36:37], v[24:25], v[24:25], v[36:37]
    v_pk_fma_f32 v[38:39], v[26:27], v[26:27], v[38:39]
    v_pk_add_f32 v[32:33], v[32:33], v[28:29]
    v_pk_add_f32 v[34:35], v[34:35], v[30:31]
    v_pk_fma_f32 v[36:37], v[28:29], v[28:29], v[36:37]
    v_pk_fma_f32 v[38:39], v[30:31], v[30:31], v[38:39]
    s_nop 0
    v_permlane32_swap_b32 v32, v36
    v_permlane32_swap_b32 v33, v37
    v_permlane32_swap_b32 v34, v38
    v_permlane32_swap_b32 v35, v39
    v_pk_add_f32 v[32:33], v[32:33], v[36:37]
    v_pk_add_f32 v[34:35], v[34:35], v[38:39]
    s_nop 1
    v_permlane16_swap_b32 v32, v34
    v_permlane16_swap_b32 v33, v35
    v_pk_add_f32 v[32:33], v[32:33], v[34:35]
    s_nop 1
    v_add_f32_dpp v32, v32, v32 row_ror:8 row_mask:0xf bank_mask:0xf
    v_add_f32_dpp v33, v33, v33 row_ror:8 row_mask:0xf bank_mask:0xf
    s_nop 0
    v_add_f32_dpp v32, v32, v32 quad_perm:[1,0,3,2] row_mask:0xf bank_mask:0xf
    v_add_f32_dpp v33, v33, v33 quad_perm:[1,0,3,2] row_mask:0xf bank_mask:0xf
    s_nop 0
    v_add_f32_dpp v32, v32, v32 quad_perm:[2,3,0,1] row_mask:0xf bank_mask:0xf
    v_add_f32_dpp v33, v33, v33 quad_perm:[2,3,0,1] row_mask:0xf bank_mask:0xf
    s_mov_b64 exec, s[8:9]
    ds_add_f32 v4, v32 offset:0
    ds_add_f32 v4, v33 offset:4
    s_mov_b64 exec, -1
    s_waitcnt vmcnt(0)
    v_mov_b32 v52, 1
    v_mov_b32 v53, 163012
    s_mov_b64 exec, 1
    ds_add_rtn_u32 v54, v53, v52
    s_lshl_b32 s57, s54, 7
    s_add_u32 s58, s57, 4096
    s_add_u32 s59, s57, 12288
    s_waitcnt lgkmcnt(0)
    v_readfirstlane_b32 s57, v54
    s_nop 0
    s_cmp_lg_u32 s57, 3
    s_cbranch_scc1 arr_1
    buffer_atomic_add v52, v11, s[36:39], s58 offen sc0 sc1
    s_waitcnt vmcnt(0)
    v_readfirstlane_b32 s57, v52
    s_nop 0
    s_sub_u32 s57, s57, s56
    s_cmp_lg_u32 s57, 15
    s_cbranch_scc1 arr_1
    s_mov_b64 exec, -1
    v_mov_b32 v52, s53
    v_mov_b32 v53, s53
    v_mov_b32 v54, s53
    v_mov_b32 v55, s53
    s_mov_b64 exec, 0xff
    buffer_store_dwordx4 v[52:55], v11, s[36:39], s59 offen sc1
    s_mov_b64 exec, -1
arr_1:
    s_mov_b64 exec, -1
    v_mov_b32 v106, 0x3a800000
    v_mov_b32 v107, 0x3727c5ac
    v_lshrrev_b32 v12, 3, v6
    v_and_b32 v15, 3, v6
    v_lshl_add_u32 v12, v12, 2, v15
    v_and_b32 v15, 7, v12
    v_lshlrev_b32 v10, 2, v7
    v_xor_b32 v15, v15, v10
    v_lshlrev_b32 v15, 4, v15
    v_lshl_add_u32 v12, v12, 7, v15
    v_and_b32 v15, 4, v6
    v_lshl_add_u32 v12, v15, 1, v12
    v_add_u32 v12, 86016, v12
    v_xor_b32 v100, 0, v12
    v_xor_b32 v101, 16, v12
    v_xor_b32 v102, 32, v12
    v_xor_b32 v103, 48, v12
    v_bfe_u32 v104, v0, 3, 5
    v_and_b32 v13, 7, v0
    v_and_b32 v15, 7, v104
    v_xor_b32 v14, v15, v13
    v_lshlrev_b32 v14, 4, v14
    v_lshl_add_u32 v14, v104, 7, v14
    v_add_u32 v14, 86016, v14
    v_lshlrev_b32 v15, 8, v15
    v_lshl_add_u32 v15, v13, 4, v15
    v_lshrrev_b32 v104, 3, v104
    v_lshl_add_u32 v15, v104, 18, v15
    s_lshr_b32 s3, s1, 1
    s_lshl_b32 s3, s3, 11
    s_and_b32 s57, s1, 1
    s_lshl_b32 s57, s57, 7
    s_add_u32 s3, s3, s57
    v_add_u32 v15, s3, v15
    v_lshlrev_b32 v12, 6, v6
    v_lshl_add_u32 v12, v7, 5, v12
    s_lshl_b32 s3, s1, 14
    s_add_u32 s3, s3, 5242880
    v_add_u32 v12, s3, v12
    v_lshlrev_b32 v13, 4, v6
    v_add_u32 v13, 135168, v13
    s_cmp_lg_u32 s52, 0
    s_cbranch_scc1 L_ln
    v_lshlrev_b32 v47, 7, v8
    s_movk_i32 s3, 12288
    s_mov_b32 s57, 0
poll_2:
    buffer_load_dword v48, v47, s[36:39], s3 offen sc1
    s_waitcnt vmcnt(0)
    v_cmp_ne_u32 vcc, s53, v48
    s_nop 1
    s_cbranch_vccz pdone_3
    s_add_u32 s57, s57, 1
    s_cmp_lt_u32 s57, 0x40000
    s_cbranch_scc1 poll_2
pdone_3:
    s_branch L_ln
L_b1:
    s_cmp_lg_u32 s52, 7
    s_cbranch_scc1 L_b1g
    s_lshr_b32 s3, s55, 1
    s_lshl_b32 s3, s3, 7
    v_and_b32 v47, 1, v9
    v_subrev_u32 v47, 1, v47
    v_and_b32 v47, s3, v47
    v_lshl_add_u32 v47, v8, 10, v47
    v_and_b32 v46, 3, v2
    v_xor_b32 v46, v46, v9
    v_lshlrev_b32 v46, 4, v46
    v_lshrrev_b32 v45, 2, v2
    v_lshl_add_u32 v46, v45, 6, v46
    s_lshl_b32 s3, s54, 14
    s_add_u32 s3, s3, 786432
    s_lshl_b32 s58, s0, 14
    s_add_u32 s58, s58, 1048576
    s_mov_b32 s57, 0
poll_4:
    buffer_load_dword v48, v47, s[36:39], s3 offen sc1
    s_waitcnt vmcnt(0)
    v_cmp_ne_u32 vcc, s53, v48
    s_nop 1
    s_cbranch_vccz pdone_5
    s_add_u32 s57, s57, 1
    s_cmp_lt_u32 s57, 0x40000
    s_cbranch_scc1 poll_4
pdone_5:
    s_mov_b32 m0, 66560
    s_nop 0
    buffer_load_dwordx4 v46, s[36:39], s58 offen offset:0 sc1 lds
    buffer_load_dwordx4 v46, s[36:39], s58 offen offset:1024 sc1 lds
    buffer_load_dwordx4 v46, s[36:39], s58 offen offset:2048 sc1 lds
    buffer_load_dwordx4 v46, s[36:39], s58 offen offset:3072 sc1 lds
    s_add_u32 s58, s58, 4096
    s_mov_b32 m0, 70656
    s_nop 0
    buffer_load_dwordx4 v46, s[36:39], s58 offen offset:0 sc1 lds
    buffer_load_dwordx4 v46, s[36:39], s58 offen offset:1024 sc1 lds
    buffer_load_dwordx4 v46, s[36:39], s58 offen offset:2048 sc1 lds
    buffer_load_dwordx4 v46, s[36:39], s58 offen offset:3072 sc1 lds
    s_add_u32 s58, s58, 4096
    s_mov_b32 m0, 74752
    s_nop 0
    buffer_load_dwordx4 v46, s[36:39], s58 offen offset:0 sc1 lds
    buffer_load_dwordx4 v46, s[36:39], s58 offen offset:1024 sc1 lds
    buffer_load_dwordx4 v46, s[36:39], s58 offen offset:2048 sc1 lds
    buffer_load_dwordx4 v46, s[36:39], s58 offen offset:3072 sc1 lds
    s_add_u32 s58, s58, 4096
    s_mov_b32 m0, 78848
    s_nop 0
    buffer_load_dwordx4 v46, s[36:39], s58 offen offset:0 sc1 lds
    buffer_load_dwordx4 v46, s[36:39], s58 offen offset:1024 sc1 lds
    buffer_load_dwordx4 v46, s[36:39], s58 offen offset:2048 sc1 lds
    buffer_load_dwordx4 v46, s[36:39], s58 offen offset:3072 sc1 lds
    s_and_b32 s57, s2, 7
    s_lshr_b32 s58, s2, 3
    s_and_b32 s60, s57, 1
    s_lshl_b32 s60, s60, 3
    s_and_b32 s3, s58, 7
    s_add_u32 s60, s60, s3
    s_lshr_b32 s61, s57, 1
    s_lshl_b32 s61, s61, 2
    s_lshr_b32 s3, s58, 3
    s_add_u32 s61, s61, s3
    s_mul_i32 s62, s61, 448
    s_and_b32 s3, s61, 1
    s_cmp_eq_u32 s3, 0
    s_cselect_b32 s63, 384, 0
    s_cselect_b32 s3, 0, 64
    s_add_u32 s63, s63, s62
    s_add_u32 s62, s62, s3
    s_sub_u32 s64, s52, 4
    s_lshl_b32 s3, s60, 3
    s_lshl_b32 s57, s64, 1
    s_add_u32 s3, s3, s57
    s_lshl_b32 s3, s3, 11
    s_add_u32 s3, s3, 13631488
    v_lshlrev_b32 v200, 4, v2
    v_add_u32 v200, s3, v200
    v_lshrrev_b32 v212, 3, v2
    v_lshrrev_b32 v213, 1, v212
    v_lshlrev_b32 v213, 1, v213
    v_and_b32 v214, 7, v2
    v_xor_b32 v213, v213, v214
    v_lshlrev_b32 v213, 4, v213
    s_movk_i32 s3, 7168
    v_mul_lo_u32 v212, v212, s3
    v_add_u32 v212, v212, v213
    s_mul_i32 s3, s64, 114688
    s_add_u32 s3, s3, s62
    v_add_u32 v212, s3, v212
    v_add_u32 v204, 0, v212
    v_add_u32 v205, 56320, v212
    v_add_u32 v206, 128, v212
    v_add_u32 v207, 56448, v212
    v_add_u32 v208, 256, v212
    v_add_u32 v209, 56576, v212
    v_lshrrev_b32 v212, 2, v2
    v_bfe_u32 v213, v2, 4, 1
    v_and_b32 v214, 3, v2
    v_xor_b32 v213, v213, v214
    v_lshlrev_b32 v213, 4, v213
    s_movk_i32 s3, 7168
    v_mul_lo_u32 v212, v212, s3
    v_add_u32 v212, v212, v213
    s_mul_i32 s3, s64, 114688
    s_add_u32 s3, s3, s63
    v_add_u32 v210, s3, v212
    s_mov_b32 s65, 0
    s_mov_b32 s66, 0
    s_add_u32 s10, s60, s61
    s_and_b32 s10, s10, 3
    s_lshl_b32 s67, s64, 12
    s_add_u32 s67, s67, 86016
    s_lshl_b32 s68, s64, 11
    s_lshl_b32 s69, s64, 10
    s_sub_u32 s69, 24576, s69
    s_add_u32 s70, s67, 49152
    s_add_u32 s71, s68, 86016
    s_mov_b32 s40, s18
    s_mov_b32 s41, s19
    s_mov_b32 s42, 7340032
    s_mov_b32 s43, 0x20000
    s_mov_b32 s48, s4
    s_mov_b32 s49, s5
    s_mov_b32 s50, 4194304
    s_mov_b32 s51, 0x20000
    v_lshrrev_b32 v48, 3, v0
    v_and_b32 v49, 3, v0
    v_lshl_add_u32 v48, v48, 2, v49
    v_bfe_u32 v49, v0, 2, 1
    v_lshlrev_b32 v48, 3, v48
    v_lshl_add_u32 v48, v49, 13, v48
    s_lshl_b32 s3, s1, 14
    v_add_u32 v48, s3, v48
    v_add_u32 v49, 4096, v48
    s_lshr_b32 s58, s2, 3
    s_lshl_b32 s58, s58, 1
    s_and_b32 s57, s2, 1
    s_add_u32 s58, s58, s57
    s_mul_i32 s58, s58, 7168
    s_bfe_u32 s57, s2, 0x20001
    s_mul_i32 s57, s57, 1792
    s_add_u32 s58, s58, s57
    s_add_u32 s16, s18, s58
    s_addc_u32 s17, s19, 0
    s_waitcnt vmcnt(0)
    s_barrier
    s_sleep 8
    buffer_load_dwordx2 v[240:241], v48, s[48:51], 0 offen offset:0 nt
    buffer_load_dwordx2 v[242:243], v48, s[48:51], 0 offen offset:2048 nt
    buffer_load_dwordx2 v[244:245], v49, s[48:51], 0 offen offset:0 nt
    buffer_load_dwordx2 v[246:247], v49, s[48:51], 0 offen offset:2048 nt
    v_and_b32 v50, 3, v2
    v_lshlrev_b32 v50, 7, v50
    v_bfe_u32 v51, v2, 2, 2
    v_lshl_add_u32 v50, v51, 17, v50
    s_lshl_b32 s3, s1, 9
    s_add_u32 s3, s3, 131072
    buffer_load_dword v51, v50, s[36:39], s3 offen sc1
    v_and_b32 v50, 0x180, v50
    s_add_u32 s3, s3, 41811968
    buffer_load_dword v51, v50, s[36:39], s3 offen sc1
    s_mov_b32 s44, s20
    s_mov_b32 s45, s21
    s_mov_b32 s46, 7168
    s_mov_b32 s47, 0x20000
    s_mul_i32 s3, s61, 448
    buffer_load_dword v51, v50, s[44:47], s3 offen offset:60
    s_mov_b32 s44, s24
    s_mov_b32 s45, s25
    s_mov_b32 s46, 2048
    s_mov_b32 s47, 0x20000
    s_lshr_b32 s3, s2, 5
    s_lshl_b32 s3, s3, 8
    v_and_b32 v50, 0x80, v50
    buffer_load_dword v51, v50, s[44:47], s3 offen
    s_waitcnt vmcnt(0)
    v_lshrrev_b32 v6, 3, v0
    v_and_b32 v7, 3, v0
    v_lshl_add_u32 v6, v6, 2, v7
    v_bfe_u32 v7, v0, 2, 1
    s_mov_b32 s8, 0x00110011
    s_mov_b32 s9, s8
    v_lshrrev_b32 v4, 4, v2
    v_lshlrev_b32 v4, 3, v4
    v_lshlrev_b32 v5, 5, v7
    v_add_u32 v5, 162816, v5
    v_add_u32 v4, v4, v5
    v_lshlrev_b32 v16, 16, v240
    v_and_b32 v20, 0xffff0000, v240
    v_lshlrev_b32 v24, 16, v241
    v_and_b32 v28, 0xffff0000, v241
    v_lshlrev_b32 v17, 16, v242
    v_and_b32 v21, 0xffff0000, v242
    v_lshlrev_b32 v25, 16, v243
    v_and_b32 v29, 0xffff0000, v243
    v_lshlrev_b32 v18, 16, v244
    v_and_b32 v22, 0xffff0000, v244
    v_lshlrev_b32 v26, 16, v245
    v_and_b32 v30, 0xffff0000, v245
    v_lshlrev_b32 v19, 16, v246
    v_and_b32 v23, 0xffff0000, v246
    v_lshlrev_b32 v27, 16, v247
    v_and_b32 v31, 0xffff0000, v247
    v_pk_add_f32 v[32:33], v[16:17], v[20:21]
    v_pk_add_f32 v[34:35], v[18:19], v[22:23]
    v_pk_mul_f32 v[36:37], v[16:17], v[16:17]
    v_pk_mul_f32 v[38:39], v[18:19], v[18:19]
    v_pk_fma_f32 v[36:37], v[20:21], v[20:21], v[36:37]
    v_pk_fma_f32 v[38:39], v[22:23], v[22:23], v[38:39]
    v_pk_add_f32 v[32:33], v[32:33], v[24:25]
    v_pk_add_f32 v[34:35], v[34:35], v[26:27]
    v_pk_fma_f32 v[36:37], v[24:25], v[24:25], v[36:37]
    v_pk_fma_f32 v[38:39], v[26:27], v[26:27], v[38:39]
    v_pk_add_f32 v[32:33], v[32:33], v[28:29]
    v_pk_add_f32 v[34:35], v[34:35], v[30:31]
    v_pk_fma_f32 v[36:37], v[28:29], v[28:29], v[36:37]
    v_pk_fma_f32 v[38:39], v[30:31], v[30:31], v[38:39]
    s_nop 0
    v_permlane32_swap_b32 v32, v36
    v_permlane32_swap_b32 v33, v37
    v_permlane32_swap_b32 v34, v38
    v_permlane32_swap_b32 v35, v39
    v_pk_add_f32 v[32:33], v[32:33], v[36:37]
    v_pk_add_f32 v[34:35], v[34:35], v[38:39]
    s_nop 1
    v_permlane16_swap_b32 v32, v34
    v_permlane16_swap_b32 v33, v35
    v_pk_add_f32 v[32:33], v[32:33], v[34:35]
    s_nop 1
    v_add_f32_dpp v32, v32, v32 row_ror:8 row_mask:0xf bank_mask:0xf
    v_add_f32_dpp v33, v33, v33 row_ror:8 row_mask:0xf bank_mask:0xf
    s_nop 0
    v_add_f32_dpp v32, v32, v32 quad_perm:[1,0,3,2] row_mask:0xf bank_mask:0xf
    v_add_f32_dpp v33, v33, v33 quad_perm:[1,0,3,2] row_mask:0xf bank_mask:0xf
    s_nop 0
    v_add_f32_dpp v32, v32, v32 quad_perm:[2,3,0,1] row_mask:0xf bank_mask:0xf
    v_add_f32_dpp v33, v33, v33 quad_perm:[2,3,0,1] row_mask:0xf bank_mask:0xf
    s_mov_b64 exec, s[8:9]
    ds_add_f32 v4, v32 offset:0
    ds_add_f32 v4, v33 offset:4
    s_mov_b64 exec, -1
    s_branch L_b1m
L_b1g:
    s_and_b32 s57, s2, 7
    s_lshr_b32 s58, s2, 3
    s_and_b32 s60, s57, 1
    s_lshl_b32 s60, s60, 3
    s_and_b32 s3, s58, 7
    s_add_u32 s60, s60, s3
    s_lshr_b32 s61, s57, 1
    s_lshl_b32 s61, s61, 2
    s_lshr_b32 s3, s58, 3
    s_add_u32 s61, s61, s3
    s_mul_i32 s62, s61, 448
    s_and_b32 s3, s61, 1
    s_cmp_eq_u32 s3, 0
    s_cselect_b32 s63, 384, 0
    s_cselect_b32 s3, 0, 64
    s_add_u32 s63, s63, s62
    s_add_u32 s62, s62, s3
    s_sub_u32 s64, s52, 4
    s_lshl_b32 s3, s60, 3
    s_lshl_b32 s57, s64, 1
    s_add_u32 s3, s3, s57
    s_lshl_b32 s3, s3, 11
    s_add_u32 s3, s3, 13631488
    v_lshlrev_b32 v200, 4, v2
    v_add_u32 v200, s3, v200
    v_lshrrev_b32 v212, 3, v2
    v_lshrrev_b32 v213, 1, v212
    v_lshlrev_b32 v213, 1, v213
    v_and_b32 v214, 7, v2
    v_xor_b32 v213, v213, v214
    v_lshlrev_b32 v213, 4, v213
    s_movk_i32 s3, 7168
    v_mul_lo_u32 v212, v212, s3
    v_add_u32 v212, v212, v213
    s_mul_i32 s3, s64, 114688
    s_add_u32 s3, s3, s62
    v_add_u32 v212, s3, v212
    v_add_u32 v204, 0, v212
    v_add_u32 v205, 56320, v212
    v_add_u32 v206, 128, v212
    v_add_u32 v207, 56448, v212
    v_add_u32 v208, 256, v212
    v_add_u32 v209, 56576, v212
    v_lshrrev_b32 v212, 2, v2
    v_bfe_u32 v213, v2, 4, 1
    v_and_b32 v214, 3, v2
    v_xor_b32 v213, v213, v214
    v_lshlrev_b32 v213, 4, v213
    s_movk_i32 s3, 7168
    v_mul_lo_u32 v212, v212, s3
    v_add_u32 v212, v212, v213
    s_mul_i32 s3, s64, 114688
    s_add_u32 s3, s3, s63
    v_add_u32 v210, s3, v212
    s_mov_b32 s65, 0
    s_mov_b32 s66, 0
    s_add_u32 s10, s60, s61
    s_and_b32 s10, s10, 3
    s_lshl_b32 s67, s64, 12
    s_add_u32 s67, s67, 86016
    s_lshl_b32 s68, s64, 11
    s_lshl_b32 s69, s64, 10
    s_sub_u32 s69, 24576, s69
    s_add_u32 s70, s67, 49152
    s_add_u32 s71, s68, 86016
    s_mov_b32 s40, s18
    s_mov_b32 s41, s19
    s_mov_b32 s42, 7340032
    s_mov_b32 s43, 0x20000
    s_mov_b32 s3, 0xbfb8aa3b
    v_lshlrev_b32 v16, 16, v220
    v_and_b32 v17, 0xffff0000, v220
    v_mul_f32 v18, s3, v16
    v_mul_f32 v19, s3, v17
    v_exp_f32 v18, v18
    v_exp_f32 v19, v19
    v_add_f32 v18, 1.0, v18
    v_add_f32 v19, 1.0, v19
    v_rcp_f32 v18, v18
    v_rcp_f32 v19, v19
    v_mul_f32 v18, v18, v16
    v_mul_f32 v19, v19, v17
    v_cvt_pk_bf16_f32 v18, v18, v19
    s_lshl_b32 s58, s64, 9
    s_add_u32 s58, s58, 151552
    v_lshlrev_b32 v20, 2, v2
    v_add_u32 v21, s58, v20
    ds_write_b32 v21, v18
    v_lshlrev_b32 v22, 3, v9
    v_add_u32 v22, s58, v22
    ds_read_b64 v[64:65], v22 offset:0
    ds_read_b64 v[66:67], v22 offset:32
    ds_read_b64 v[68:69], v22 offset:64
    ds_read_b64 v[70:71], v22 offset:96
    ds_read_b64 v[72:73], v22 offset:128
    ds_read_b64 v[74:75], v22 offset:160
    ds_read_b64 v[76:77], v22 offset:192
    ds_read_b64 v[78:79], v22 offset:224
    v_lshrrev_b32 v24, 3, v2
    v_lshrrev_b32 v25, 1, v24
    v_lshlrev_b32 v25, 1, v25
    v_and_b32 v26, 7, v2
    v_xor_b32 v25, v25, v26
    v_lshlrev_b32 v25, 4, v25
    s_movk_i32 s3, 12288
    v_mul_lo_u32 v24, v24, s3
    v_add_u32 v24, v24, v25
    v_add_u32 v25, 97280, v24
    v_add_u32 v26, 194560, v24
    v_add_u32 v27, 291840, v24
    s_and_b32 s3, s55, 7
    s_mul_i32 s3, s3, 1572864
    s_lshr_b32 s57, s0, 3
    s_mul_i32 s57, s57, 384
    s_add_u32 s3, s3, s57
    s_lshl_b32 s57, s64, 7
    s_add_u32 s48, s3, s57
    s_lshl_b32 s49, s64, 14
    s_add_u32 s49, s49, 102400
    v_lshrrev_b32 v28, 2, v2
    v_and_b32 v28, 7, v28
    v_lshrrev_b32 v29, 1, v28
    v_lshlrev_b32 v29, 5, v29
    v_lshl_add_u32 v29, v28, 7, v29
    v_and_b32 v28, 3, v2
    v_lshl_add_u32 v29, v28, 3, v29
    v_lshrrev_b32 v28, 5, v2
    v_lshl_add_u32 v29, v28, 10, v29
    v_add_u32 v29, s49, v29
    v_xor_b32 v56, 0, v29
    v_xor_b32 v57, 32, v29
    v_xor_b32 v58, 64, v29
    v_xor_b32 v59, 96, v29
    v_lshlrev_b32 v23, 4, v9
    v_add_u32 v23, s58, v23
    s_mov_b32 s44, s28
    s_mov_b32 s45, s29
    s_mov_b32 s46, 12582912
    s_mov_b32 s47, 0x20000
    s_mov_b32 s58, s48
    s_mov_b32 s59, s49
    s_mov_b32 s48, s4
    s_mov_b32 s49, s5
    s_mov_b32 s50, 4194304
    s_mov_b32 s51, 0x20000
    v_lshrrev_b32 v48, 3, v0
    v_and_b32 v49, 3, v0
    v_lshl_add_u32 v48, v48, 2, v49
    v_bfe_u32 v49, v0, 2, 1
    v_lshlrev_b32 v48, 3, v48
    v_lshl_add_u32 v48, v49, 13, v48
    s_lshl_b32 s3, s1, 14
    v_add_u32 v48, s3, v48
    v_add_u32 v49, 4096, v48
    s_waitcnt lgkmcnt(0)
    s_barrier
    s_sleep 2
    s_add_u32 m0, s59, 0
    s_nop 0
    buffer_load_dwordx4 v24, s[44:47], s58 offen offset:0 nt lds
    buffer_load_dwordx4 v25, s[44:47], s58 offen offset:1024 nt lds
    buffer_load_dwordx4 v26, s[44:47], s58 offen offset:2048 nt lds
    buffer_load_dwordx4 v27, s[44:47], s58 offen offset:3072 nt lds
    s_add_u32 s58, s58, 393216
    s_add_u32 m0, s59, 4096
    s_nop 0
    buffer_load_dwordx4 v24, s[44:47], s58 offen offset:0 nt lds
    buffer_load_dwordx4 v25, s[44:47], s58 offen offset:1024 nt lds
    buffer_load_dwordx4 v26, s[44:47], s58 offen offset:2048 nt lds
    buffer_load_dwordx4 v27, s[44:47], s58 offen offset:3072 nt lds
    s_add_u32 s58, s58, 393216
    s_add_u32 m0, s59, 8192
    s_nop 0
    buffer_load_dwordx4 v24, s[44:47], s58 offen offset:0 nt lds
    buffer_load_dwordx4 v25, s[44:47], s58 offen offset:1024 nt lds
    buffer_load_dwordx4 v26, s[44:47], s58 offen offset:2048 nt lds
    buffer_load_dwordx4 v27, s[44:47], s58 offen offset:3072 nt lds
    s_add_u32 s58, s58, 393216
    s_add_u32 m0, s59, 12288
    s_nop 0
    buffer_load_dwordx4 v24, s[44:47], s58 offen offset:0 nt lds
    buffer_load_dwordx4 v25, s[44:47], s58 offen offset:1024 nt lds
    buffer_load_dwordx4 v26, s[44:47], s58 offen offset:2048 nt lds
    buffer_load_dwordx4 v27, s[44:47], s58 offen offset:3072 nt lds
    buffer_load_dwordx2 v[240:241], v48, s[48:51], 0 offen offset:0 nt
    buffer_load_dwordx2 v[242:243], v48, s[48:51], 0 offen offset:2048 nt
    buffer_load_dwordx2 v[244:245], v49, s[48:51], 0 offen offset:0 nt
    buffer_load_dwordx2 v[246:247], v49, s[48:51], 0 offen offset:2048 nt
    s_setprio 3
    s_waitcnt vmcnt(16)
    ds_read_b64_tr_b16 v[96:97], v56 offset:0
    ds_read_b64_tr_b16 v[98:99], v56 offset:2048
    ds_read_b64_tr_b16 v[100:101], v57 offset:0
    ds_read_b64_tr_b16 v[102:103], v57 offset:2048
    ds_read_b64_tr_b16 v[104:105], v58 offset:0
    ds_read_b64_tr_b16 v[106:107], v58 offset:2048
    ds_read_b64_tr_b16 v[108:109], v59 offset:0
    ds_read_b64_tr_b16 v[110:111], v59 offset:2048
    s_waitcnt lgkmcnt(0)
    v_mfma_f32_16x16x32_bf16 v[80:83], v[96:99], v[64:67], 0
    v_mfma_f32_16x16x32_bf16 v[84:87], v[100:103], v[64:67], 0
    v_mfma_f32_16x16x32_bf16 v[88:91], v[104:107], v[64:67], 0
    v_mfma_f32_16x16x32_bf16 v[92:95], v[108:111], v[64:67], 0
    s_waitcnt vmcnt(12)
    ds_read_b64_tr_b16 v[96:97], v56 offset:4096
    ds_read_b64_tr_b16 v[98:99], v56 offset:6144
    ds_read_b64_tr_b16 v[100:101], v57 offset:4096
    ds_read_b64_tr_b16 v[102:103], v57 offset:6144
    ds_read_b64_tr_b16 v[104:105], v58 offset:4096
    ds_read_b64_tr_b16 v[106:107], v58 offset:6144
    ds_read_b64_tr_b16 v[108:109], v59 offset:4096
    ds_read_b64_tr_b16 v[110:111], v59 offset:6144
    s_waitcnt lgkmcnt(0)
    v_mfma_f32_16x16x32_bf16 v[80:83], v[96:99], v[68:71], v[80:83]
    v_mfma_f32_16x16x32_bf16 v[84:87], v[100:103], v[68:71], v[84:87]
    v_mfma_f32_16x16x32_bf16 v[88:91], v[104:107], v[68:71], v[88:91]
    v_mfma_f32_16x16x32_bf16 v[92:95], v[108:111], v[68:71], v[92:95]
    s_waitcnt vmcnt(8)
    ds_read_b64_tr_b16 v[96:97], v56 offset:8192
    ds_read_b64_tr_b16 v[98:99], v56 offset:10240
    ds_read_b64_tr_b16 v[100:101], v57 offset:8192
    ds_read_b64_tr_b16 v[102:103], v57 offset:10240
    ds_read_b64_tr_b16 v[104:105], v58 offset:8192
    ds_read_b64_tr_b16 v[106:107], v58 offset:10240
    ds_read_b64_tr_b16 v[108:109], v59 offset:8192
    ds_read_b64_tr_b16 v[110:111], v59 offset:10240
    s_waitcnt lgkmcnt(0)
    v_mfma_f32_16x16x32_bf16 v[80:83], v[96:99], v[72:75], v[80:83]
    v_mfma_f32_16x16x32_bf16 v[84:87], v[100:103], v[72:75], v[84:87]
    v_mfma_f32_16x16x32_bf16 v[88:91], v[104:107], v[72:75], v[88:91]
    v_mfma_f32_16x16x32_bf16 v[92:95], v[108:111], v[72:75], v[92:95]
    s_waitcnt vmcnt(4)
    ds_read_b64_tr_b16 v[96:97], v56 offset:12288
    ds_read_b64_tr_b16 v[98:99], v56 offset:14336
    ds_read_b64_tr_b16 v[100:101], v57 offset:12288
    ds_read_b64_tr_b16 v[102:103], v57 offset:14336
    ds_read_b64_tr_b16 v[104:105], v58 offset:12288
    ds_read_b64_tr_b16 v[106:107], v58 offset:14336
    ds_read_b64_tr_b16 v[108:109], v59 offset:12288
    ds_read_b64_tr_b16 v[110:111], v59 offset:14336
    s_waitcnt lgkmcnt(0)
    v_mfma_f32_16x16x32_bf16 v[80:83], v[96:99], v[76:79], v[80:83]
    v_mfma_f32_16x16x32_bf16 v[84:87], v[100:103], v[76:79], v[84:87]
    v_mfma_f32_16x16x32_bf16 v[88:91], v[104:107], v[76:79], v[88:91]
    v_mfma_f32_16x16x32_bf16 v[92:95], v[108:111], v[76:79], v[92:95]
    s_mov_b32 exec_lo, 0x00010001
    s_mov_b32 exec_hi, 0x00010001
    s_nop 2
    ds_write_b128 v23, v[80:83] offset:256
    ds_write_b128 v23, v[84:87] offset:320
    ds_write_b128 v23, v[88:91] offset:384
    ds_write_b128 v23, v[92:95] offset:448
    s_mov_b64 exec, -1
    ds_read_b32 v30, v21 offset:256
    s_lshr_b32 s3, s0, 3
    s_mul_i32 s3, s3, 768
    s_lshl_b32 s57, s64, 8
    s_add_u32 s3, s3, s57
    s_add_u32 s3, s3, 65536
    s_waitcnt lgkmcnt(0)
    buffer_atomic_add_f32 v30, v20, s[36:39], s3 offen sc1
    s_waitcnt vmcnt(0)
    v_mov_b32 v52, 1
    v_mov_b32 v53, 163016
    s_mov_b64 exec, 1
    ds_add_rtn_u32 v54, v53, v52
    s_lshl_b32 s57, s54, 7
    s_add_u32 s58, s57, 20480
    s_add_u32 s59, s57, 28672
    s_waitcnt lgkmcnt(0)
    v_readfirstlane_b32 s57, v54
    s_nop 0
    s_cmp_lg_u32 s57, 2
    s_cbranch_scc1 arr_6
    buffer_atomic_add v52, v11, s[36:39], s58 offen sc0 sc1
    s_waitcnt vmcnt(0)
    v_readfirstlane_b32 s57, v52
    s_nop 0
    s_sub_u32 s57, s57, s56
    s_cmp_lg_u32 s57, 15
    s_cbranch_scc1 arr_6
    s_mov_b64 exec, -1
    v_mov_b32 v52, s53
    v_mov_b32 v53, s53
    v_mov_b32 v54, s53
    v_mov_b32 v55, s53
    s_mov_b64 exec, 0xff
    buffer_store_dwordx4 v[52:55], v11, s[36:39], s59 offen sc1
    s_mov_b64 exec, -1
arr_6:
    s_mov_b64 exec, -1
    s_setprio 0
    v_lshrrev_b32 v6, 3, v0
    v_and_b32 v7, 3, v0
    v_lshl_add_u32 v6, v6, 2, v7
    v_bfe_u32 v7, v0, 2, 1
    s_mov_b32 s8, 0x00110011
    s_mov_b32 s9, s8
    v_lshrrev_b32 v4, 4, v2
    v_lshlrev_b32 v4, 3, v4
    v_lshlrev_b32 v5, 5, v7
    v_add_u32 v5, 162816, v5
    v_add_u32 v4, v4, v5
    v_lshlrev_b32 v16, 16, v240
    v_and_b32 v20, 0xffff0000, v240
    v_lshlrev_b32 v24, 16, v241
    v_and_b32 v28, 0xffff0000, v241
    v_lshlrev_b32 v17, 16, v242
    v_and_b32 v21, 0xffff0000, v242
    v_lshlrev_b32 v25, 16, v243
    v_and_b32 v29, 0xffff0000, v243
    v_lshlrev_b32 v18, 16, v244
    v_and_b32 v22, 0xffff0000, v244
    v_lshlrev_b32 v26, 16, v245
    v_and_b32 v30, 0xffff0000, v245
    v_lshlrev_b32 v19, 16, v246
    v_and_b32 v23, 0xffff0000, v246
    v_lshlrev_b32 v27, 16, v247
    v_and_b32 v31, 0xffff0000, v247
    v_pk_add_f32 v[32:33], v[16:17], v[20:21]
    v_pk_add_f32 v[34:35], v[18:19], v[22:23]
    v_pk_mul_f32 v[36:37], v[16:17], v[16:17]
    v_pk_mul_f32 v[38:39], v[18:19], v[18:19]
    v_pk_fma_f32 v[36:37], v[20:21], v[20:21], v[36:37]
    v_pk_fma_f32 v[38:39], v[22:23], v[22:23], v[38:39]
    v_pk_add_f32 v[32:33], v[32:33], v[24:25]
    v_pk_add_f32 v[34:35], v[34:35], v[26:27]
    v_pk_fma_f32 v[36:37], v[24:25], v[24:25], v[36:37]
    v_pk_fma_f32 v[38:39], v[26:27], v[26:27], v[38:39]
    v_pk_add_f32 v[32:33], v[32:33], v[28:29]
    v_pk_add_f32 v[34:35], v[34:35], v[30:31]
    v_pk_fma_f32 v[36:37], v[28:29], v[28:29], v[36:37]
    v_pk_fma_f32 v[38:39], v[30:31], v[30:31], v[38:39]
    s_nop 0
    v_permlane32_swap_b32 v32, v36
    v_permlane32_swap_b32 v33, v37
    v_permlane32_swap_b32 v34, v38
    v_permlane32_swap_b32 v35, v39
    v_pk_add_f32 v[32:33], v[32:33], v[36:37]
    v_pk_add_f32 v[34:35], v[34:35], v[38:39]
    s_nop 1
    v_permlane16_swap_b32 v32, v34
    v_permlane16_swap_b32 v33, v35
    v_pk_add_f32 v[32:33], v[32:33], v[34:35]
    s_nop 1
    v_add_f32_dpp v32, v32, v32 row_ror:8 row_mask:0xf bank_mask:0xf
    v_add_f32_dpp v33, v33, v33 row_ror:8 row_mask:0xf bank_mask:0xf
    s_nop 0
    v_add_f32_dpp v32, v32, v32 quad_perm:[1,0,3,2] row_mask:0xf bank_mask:0xf
    v_add_f32_dpp v33, v33, v33 quad_perm:[1,0,3,2] row_mask:0xf bank_mask:0xf
    s_nop 0
    v_add_f32_dpp v32, v32, v32 quad_perm:[2,3,0,1] row_mask:0xf bank_mask:0xf
    v_add_f32_dpp v33, v33, v33 quad_perm:[2,3,0,1] row_mask:0xf bank_mask:0xf
    s_mov_b64 exec, s[8:9]
    ds_add_f32 v4, v32 offset:0
    ds_add_f32 v4, v33 offset:4
    s_mov_b64 exec, -1
L_b1m:
    v_mov_b32 v106, 0x3a800000
    v_mov_b32 v107, 0x3727c5ac
    v_lshrrev_b32 v12, 3, v6
    v_and_b32 v15, 3, v6
    v_lshl_add_u32 v12, v12, 2, v15
    v_and_b32 v15, 7, v12
    v_lshlrev_b32 v10, 2, v7
    v_xor_b32 v15, v15, v10
    v_lshlrev_b32 v15, 4, v15
    v_lshl_add_u32 v12, v12, 7, v15
    v_and_b32 v15, 4, v6
    v_lshl_add_u32 v12, v15, 1, v12
    v_add_u32 v12, 86016, v12
    v_xor_b32 v100, 0, v12
    v_xor_b32 v101, 16, v12
    v_xor_b32 v102, 32, v12
    v_xor_b32 v103, 48, v12
    v_bfe_u32 v104, v0, 3, 5
    v_and_b32 v13, 7, v0
    v_and_b32 v15, 7, v104
    v_xor_b32 v14, v15, v13
    v_lshlrev_b32 v14, 4, v14
    v_lshl_add_u32 v14, v104, 7, v14
    v_add_u32 v14, 86016, v14
    v_lshlrev_b32 v15, 8, v15
    v_lshl_add_u32 v15, v13, 4, v15
    v_lshrrev_b32 v104, 3, v104
    v_lshl_add_u32 v15, v104, 18, v15
    s_lshr_b32 s3, s1, 1
    s_lshl_b32 s3, s3, 11
    s_and_b32 s57, s1, 1
    s_lshl_b32 s57, s57, 7
    s_add_u32 s3, s3, s57
    v_add_u32 v15, s3, v15
    v_lshlrev_b32 v12, 6, v6
    v_lshl_add_u32 v12, v7, 5, v12
    s_lshl_b32 s3, s1, 14
    s_add_u32 s3, s3, 5242880
    v_add_u32 v12, s3, v12
    v_lshlrev_b32 v13, 4, v6
    v_add_u32 v13, 135168, v13
    v_lshlrev_b32 v47, 7, v8
    s_movk_i32 s3, 28672
    s_mov_b32 s57, 0
poll_7:
    buffer_load_dword v48, v47, s[36:39], s3 offen sc1
    s_waitcnt vmcnt(0)
    v_cmp_ne_u32 vcc, s53, v48
    s_nop 1
    s_cbranch_vccz pdone_8
    s_sleep 4
    s_add_u32 s57, s57, 1
    s_cmp_lt_u32 s57, 0x40000
    s_cbranch_scc1 poll_7
pdone_8:
    v_and_b32 v48, 255, v0
    v_lshlrev_b32 v48, 4, v48
    s_mov_b32 s3, 65536
    buffer_load_dwordx4 v[64:67], v48, s[36:39], s3 offen sc1
    s_mov_b32 s3, 69632
    buffer_load_dwordx4 v[68:71], v48, s[36:39], s3 offen sc1
    s_mov_b32 s3, 73728
    buffer_load_dwordx4 v[72:75], v48, s[36:39], s3 offen sc1
    s_mov_b32 s3, 77824
    buffer_load_dwordx4 v[76:79], v48, s[36:39], s3 offen sc1
    s_mov_b32 s3, 81920
    buffer_load_dwordx4 v[80:83], v48, s[36:39], s3 offen sc1
    v_add_u32 v48, 135168, v48
    s_waitcnt vmcnt(0)
    v_cvt_pk_bf16_f32 v64, v64, v64
    v_cvt_pk_bf16_f32 v65, v65, v65
    v_cvt_pk_bf16_f32 v66, v66, v66
    v_cvt_pk_bf16_f32 v67, v67, v67
    v_cvt_pk_bf16_f32 v68, v68, v68
    v_cvt_pk_bf16_f32 v69, v69, v69
    v_cvt_pk_bf16_f32 v70, v70, v70
    v_cvt_pk_bf16_f32 v71, v71, v71
    v_cvt_pk_bf16_f32 v72, v72, v72
    v_cvt_pk_bf16_f32 v73, v73, v73
    v_cvt_pk_bf16_f32 v74, v74, v74
    v_cvt_pk_bf16_f32 v75, v75, v75
    v_cvt_pk_bf16_f32 v76, v76, v76
    v_cvt_pk_bf16_f32 v77, v77, v77
    v_cvt_pk_bf16_f32 v78, v78, v78
    v_cvt_pk_bf16_f32 v79, v79, v79
    v_cvt_pk_bf16_f32 v80, v80, v80
    v_cvt_pk_bf16_f32 v81, v81, v81
    v_cvt_pk_bf16_f32 v82, v82, v82
    v_cvt_pk_bf16_f32 v83, v83, v83
    v_lshlrev_b32 v64, 16, v64
    v_lshlrev_b32 v65, 16, v65
    v_lshlrev_b32 v66, 16, v66
    v_lshlrev_b32 v67, 16, v67
    v_lshlrev_b32 v68, 16, v68
    v_lshlrev_b32 v69, 16, v69
    v_lshlrev_b32 v70, 16, v70
    v_lshlrev_b32 v71, 16, v71
    v_lshlrev_b32 v72, 16, v72
    v_lshlrev_b32 v73, 16, v73
    v_lshlrev_b32 v74, 16, v74
    v_lshlrev_b32 v75, 16, v75
    v_lshlrev_b32 v76, 16, v76
    v_lshlrev_b32 v77, 16, v77
    v_lshlrev_b32 v78, 16, v78
    v_lshlrev_b32 v79, 16, v79
    v_lshlrev_b32 v80, 16, v80
    v_lshlrev_b32 v81, 16, v81
    v_lshlrev_b32 v82, 16, v82
    v_lshlrev_b32 v83, 16, v83
    v_add_f32 v68, 1.0, v68
    v_add_f32 v69, 1.0, v69
    v_add_f32 v70, 1.0, v70
    v_add_f32 v71, 1.0, v71
    v_cvt_pk_bf16_f32 v68, v68, v68
    v_cvt_pk_bf16_f32 v69, v69, v69
    v_cvt_pk_bf16_f32 v70, v70, v70
    v_cvt_pk_bf16_f32 v71, v71, v71
    v_lshlrev_b32 v68, 16, v68
    v_lshlrev_b32 v69, 16, v69
    v_lshlrev_b32 v70, 16, v70
    v_lshlrev_b32 v71, 16, v71
    v_add_f32 v80, 1.0, v80
    v_add_f32 v81, 1.0, v81
    v_add_f32 v82, 1.0, v82
    v_add_f32 v83, 1.0, v83
    v_cvt_pk_bf16_f32 v80, v80, v80
    v_cvt_pk_bf16_f32 v81, v81, v81
    v_cvt_pk_bf16_f32 v82, v82, v82
    v_cvt_pk_bf16_f32 v83, v83, v83
    v_lshlrev_b32 v80, 16, v80
    v_lshlrev_b32 v81, 16, v81
    v_lshlrev_b32 v82, 16, v82
    v_lshlrev_b32 v83, 16, v83
    v_mul_f32 v64, v64, v72
    v_mul_f32 v65, v65, v73
    v_mul_f32 v66, v66, v74
    v_mul_f32 v67, v67, v75
    v_mul_f32 v68, v68, v72
    v_mul_f32 v69, v69, v73
    v_mul_f32 v70, v70, v74
    v_mul_f32 v71, v71, v75
    ds_write_b128 v48, v[64:67] offset:0
    ds_write_b128 v48, v[68:71] offset:4096
    ds_write_b128 v48, v[76:79] offset:8192
    ds_write_b128 v48, v[80:83] offset:12288
    s_add_u32 s3, s64, 0
    v_min_u32 v222, 3, v9
    v_lshl_add_u32 v222, v222, 2, s3
    v_lshlrev_b32 v222, 6, v222
    s_lshr_b32 s3, s2, 3
    s_lshl_b32 s3, s3, 1
    s_and_b32 s57, s2, 1
    s_add_u32 s3, s3, s57
    v_add_u32 v222, s3, v222
    s_movk_i32 s3, 7168
    v_mul_lo_u32 v222, v222, s3
    v_min_u32 v223, 13, v8
    v_lshl_add_u32 v222, v223, 7, v222
    s_bfe_u32 s57, s2, 0x20001
    s_mul_i32 s57, s57, 1792
    v_add_u32 v222, s57, v222
L_ln:
    s_waitcnt lgkmcnt(0)
    s_barrier
    buffer_load_dwordx4 v[40:43], v12, s[36:39], 0 offen offset:0 sc1
    buffer_load_dwordx4 v[44:47], v12, s[36:39], 0 offen offset:16 sc1
    ds_read_b128 v[48:51], v13 offset:0
    ds_read_b128 v[52:55], v13 offset:4096
    ds_read_b128 v[56:59], v13 offset:8192
    ds_read_b128 v[60:63], v13 offset:12288
    ds_read_b128 v[88:91], v5 offset:0
    ds_read_b128 v[92:95], v5 offset:16
    s_waitcnt lgkmcnt(0)
    v_pk_mul_f32 v[88:89], v[88:89], v[106:107] op_sel_hi:[1,0]
    v_pk_mul_f32 v[90:91], v[90:91], v[106:107] op_sel_hi:[1,0]
    v_pk_fma_f32 v[92:93], v[92:93], v[106:107], v[106:107] op_sel:[0,0,1] op_sel_hi:[1,0,1]
    v_pk_fma_f32 v[94:95], v[94:95], v[106:107], v[106:107] op_sel:[0,0,1] op_sel_hi:[1,0,1]
    v_pk_fma_f32 v[92:93], v[88:89], v[88:89], v[92:93] neg_lo:[1,0,0] neg_hi:[1,0,0]
    v_pk_fma_f32 v[94:95], v[90:91], v[90:91], v[94:95] neg_lo:[1,0,0] neg_hi:[1,0,0]
    v_max_f32 v92, v107, v92
    v_max_f32 v93, v107, v93
    v_max_f32 v94, v107, v94
    v_max_f32 v95, v107, v95
    v_rsq_f32 v92, v92
    v_rsq_f32 v93, v93
    v_rsq_f32 v94, v94
    v_rsq_f32 v95, v95
    v_pk_mul_f32 v[88:89], v[88:89], v[92:93] neg_lo:[1,0] neg_hi:[1,0]
    v_pk_mul_f32 v[90:91], v[90:91], v[94:95] neg_lo:[1,0] neg_hi:[1,0]
    v_pk_fma_f32 v[72:73], v[16:17], v[92:93], v[88:89]
    v_pk_fma_f32 v[74:75], v[18:19], v[94:95], v[90:91]
    v_pk_fma_f32 v[76:77], v[20:21], v[92:93], v[88:89]
    v_pk_fma_f32 v[78:79], v[22:23], v[94:95], v[90:91]
    v_pk_fma_f32 v[80:81], v[24:25], v[92:93], v[88:89]
    v_pk_fma_f32 v[82:83], v[26:27], v[94:95], v[90:91]
    v_pk_fma_f32 v[84:85], v[28:29], v[92:93], v[88:89]
    v_pk_fma_f32 v[86:87], v[30:31], v[94:95], v[90:91]
    v_pk_fma_f32 v[72:73], v[72:73], v[52:53], v[48:49] op_sel:[0,0,0] op_sel_hi:[1,0,0]
    v_pk_fma_f32 v[74:75], v[74:75], v[52:53], v[48:49] op_sel:[0,0,0] op_sel_hi:[1,0,0]
    v_pk_fma_f32 v[76:77], v[76:77], v[52:53], v[48:49] op_sel:[0,1,1] op_sel_hi:[1,1,1]
    v_pk_fma_f32 v[78:79], v[78:79], v[52:53], v[48:49] op_sel:[0,1,1] op_sel_hi:[1,1,1]
    v_pk_fma_f32 v[80:81], v[80:81], v[54:55], v[50:51] op_sel:[0,0,0] op_sel_hi:[1,0,0]
    v_pk_fma_f32 v[82:83], v[82:83], v[54:55], v[50:51] op_sel:[0,0,0] op_sel_hi:[1,0,0]
    v_pk_fma_f32 v[84:85], v[84:85], v[54:55], v[50:51] op_sel:[0,1,1] op_sel_hi:[1,1,1]
    v_pk_fma_f32 v[86:87], v[86:87], v[54:55], v[50:51] op_sel:[0,1,1] op_sel_hi:[1,1,1]
    s_waitcnt vmcnt(0)
    s_cmp_lt_u32 s52, 4
    s_cbranch_scc1 L_nopf1
    buffer_load_dword v223, v222, s[40:43], 0 offen
L_nopf1:
    v_lshlrev_b32 v108, 16, v40
    v_and_b32 v109, 0xffff0000, v40
    v_lshlrev_b32 v110, 16, v41
    v_and_b32 v111, 0xffff0000, v41
    v_lshlrev_b32 v112, 16, v42
    v_and_b32 v113, 0xffff0000, v42
    v_lshlrev_b32 v114, 16, v43
    v_and_b32 v115, 0xffff0000, v43
    v_lshlrev_b32 v116, 16, v44
    v_and_b32 v117, 0xffff0000, v44
    v_lshlrev_b32 v118, 16, v45
    v_and_b32 v119, 0xffff0000, v45
    v_lshlrev_b32 v120, 16, v46
    v_and_b32 v121, 0xffff0000, v46
    v_lshlrev_b32 v122, 16, v47
    v_and_b32 v123, 0xffff0000, v47
    v_pk_fma_f32 v[16:17], v[72:73], v[108:109], v[16:17]
    v_pk_fma_f32 v[18:19], v[74:75], v[110:111], v[18:19]
    v_pk_fma_f32 v[20:21], v[76:77], v[112:113], v[20:21]
    v_pk_fma_f32 v[22:23], v[78:79], v[114:115], v[22:23]
    v_pk_fma_f32 v[24:25], v[80:81], v[116:117], v[24:25]
    v_pk_fma_f32 v[26:27], v[82:83], v[118:119], v[26:27]
    v_pk_fma_f32 v[28:29], v[84:85], v[120:121], v[28:29]
    v_pk_fma_f32 v[30:31], v[86:87], v[122:123], v[30:31]
    v_pk_add_f32 v[32:33], v[16:17], v[20:21]
    v_pk_add_f32 v[34:35], v[18:19], v[22:23]
    v_pk_mul_f32 v[36:37], v[16:17], v[16:17]
    v_pk_mul_f32 v[38:39], v[18:19], v[18:19]
    v_pk_fma_f32 v[36:37], v[20:21], v[20:21], v[36:37]
    v_pk_fma_f32 v[38:39], v[22:23], v[22:23], v[38:39]
    v_pk_add_f32 v[32:33], v[32:33], v[24:25]
    v_pk_add_f32 v[34:35], v[34:35], v[26:27]
    v_pk_fma_f32 v[36:37], v[24:25], v[24:25], v[36:37]
    v_pk_fma_f32 v[38:39], v[26:27], v[26:27], v[38:39]
    v_pk_add_f32 v[32:33], v[32:33], v[28:29]
    v_pk_add_f32 v[34:35], v[34:35], v[30:31]
    v_pk_fma_f32 v[36:37], v[28:29], v[28:29], v[36:37]
    v_pk_fma_f32 v[38:39], v[30:31], v[30:31], v[38:39]
    s_nop 0
    v_permlane32_swap_b32 v32, v36
    v_permlane32_swap_b32 v33, v37
    v_permlane32_swap_b32 v34, v38
    v_permlane32_swap_b32 v35, v39
    v_pk_add_f32 v[32:33], v[32:33], v[36:37]
    v_pk_add_f32 v[34:35], v[34:35], v[38:39]
    s_nop 1
    v_permlane16_swap_b32 v32, v34
    v_permlane16_swap_b32 v33, v35
    v_pk_add_f32 v[32:33], v[32:33], v[34:35]
    s_nop 1
    v_add_f32_dpp v32, v32, v32 row_ror:8 row_mask:0xf bank_mask:0xf
    v_add_f32_dpp v33, v33, v33 row_ror:8 row_mask:0xf bank_mask:0xf
    s_nop 0
    v_add_f32_dpp v32, v32, v32 quad_perm:[1,0,3,2] row_mask:0xf bank_mask:0xf
    v_add_f32_dpp v33, v33, v33 quad_perm:[1,0,3,2] row_mask:0xf bank_mask:0xf
    s_nop 0
    v_add_f32_dpp v32, v32, v32 quad_perm:[2,3,0,1] row_mask:0xf bank_mask:0xf
    v_add_f32_dpp v33, v33, v33 quad_perm:[2,3,0,1] row_mask:0xf bank_mask:0xf
    s_mov_b64 exec, s[8:9]
    ds_add_f32 v4, v32 offset:64
    ds_add_f32 v4, v33 offset:68
    s_mov_b64 exec, -1
    v_cvt_pk_bf16_f32 v240, v16, v20
    v_cvt_pk_bf16_f32 v241, v24, v28
    v_cvt_pk_bf16_f32 v242, v17, v21
    v_cvt_pk_bf16_f32 v243, v25, v29
    v_cvt_pk_bf16_f32 v244, v18, v22
    v_cvt_pk_bf16_f32 v245, v26, v30
    v_cvt_pk_bf16_f32 v246, v19, v23
    v_cvt_pk_bf16_f32 v247, v27, v31
    s_waitcnt lgkmcnt(0)
    s_barrier
    ds_read_b128 v[88:91], v5 offset:64
    ds_read_b128 v[92:95], v5 offset:80
    s_waitcnt lgkmcnt(0)
    v_pk_mul_f32 v[88:89], v[88:89], v[106:107] op_sel_hi:[1,0]
    v_pk_mul_f32 v[90:91], v[90:91], v[106:107] op_sel_hi:[1,0]
    v_pk_fma_f32 v[92:93], v[92:93], v[106:107], v[106:107] op_sel:[0,0,1] op_sel_hi:[1,0,1]
    v_pk_fma_f32 v[94:95], v[94:95], v[106:107], v[106:107] op_sel:[0,0,1] op_sel_hi:[1,0,1]
    v_pk_fma_f32 v[92:93], v[88:89], v[88:89], v[92:93] neg_lo:[1,0,0] neg_hi:[1,0,0]
    v_pk_fma_f32 v[94:95], v[90:91], v[90:91], v[94:95] neg_lo:[1,0,0] neg_hi:[1,0,0]
    v_max_f32 v92, v107, v92
    v_max_f32 v93, v107, v93
    v_max_f32 v94, v107, v94
    v_max_f32 v95, v107, v95
    v_rsq_f32 v92, v92
    v_rsq_f32 v93, v93
    v_rsq_f32 v94, v94
    v_rsq_f32 v95, v95
    v_pk_mul_f32 v[88:89], v[88:89], v[92:93] neg_lo:[1,0] neg_hi:[1,0]
    v_pk_mul_f32 v[90:91], v[90:91], v[94:95] neg_lo:[1,0] neg_hi:[1,0]
    v_pk_fma_f32 v[72:73], v[16:17], v[92:93], v[88:89]
    v_pk_fma_f32 v[74:75], v[18:19], v[94:95], v[90:91]
    v_pk_fma_f32 v[76:77], v[20:21], v[92:93], v[88:89]
    v_pk_fma_f32 v[78:79], v[22:23], v[94:95], v[90:91]
    v_pk_fma_f32 v[80:81], v[24:25], v[92:93], v[88:89]
    v_pk_fma_f32 v[82:83], v[26:27], v[94:95], v[90:91]
    v_pk_fma_f32 v[84:85], v[28:29], v[92:93], v[88:89]
    v_pk_fma_f32 v[86:87], v[30:31], v[94:95], v[90:91]
    v_pk_fma_f32 v[72:73], v[72:73], v[60:61], v[56:57] op_sel:[0,0,0] op_sel_hi:[1,0,0]
    v_pk_fma_f32 v[74:75], v[74:75], v[60:61], v[56:57] op_sel:[0,0,0] op_sel_hi:[1,0,0]
    v_pk_fma_f32 v[76:77], v[76:77], v[60:61], v[56:57] op_sel:[0,1,1] op_sel_hi:[1,1,1]
    v_pk_fma_f32 v[78:79], v[78:79], v[60:61], v[56:57] op_sel:[0,1,1] op_sel_hi:[1,1,1]
    v_pk_fma_f32 v[80:81], v[80:81], v[62:63], v[58:59] op_sel:[0,0,0] op_sel_hi:[1,0,0]
    v_pk_fma_f32 v[82:83], v[82:83], v[62:63], v[58:59] op_sel:[0,0,0] op_sel_hi:[1,0,0]
    v_pk_fma_f32 v[84:85], v[84:85], v[62:63], v[58:59] op_sel:[0,1,1] op_sel_hi:[1,1,1]
    v_pk_fma_f32 v[86:87], v[86:87], v[62:63], v[58:59] op_sel:[0,1,1] op_sel_hi:[1,1,1]
    v_pk_add_f32 v[32:33], v[72:73], v[76:77]
    v_pk_add_f32 v[34:35], v[74:75], v[78:79]
    v_pk_mul_f32 v[36:37], v[72:73], v[72:73]
    v_pk_mul_f32 v[38:39], v[74:75], v[74:75]
    v_pk_fma_f32 v[36:37], v[76:77], v[76:77], v[36:37]
    v_pk_fma_f32 v[38:39], v[78:79], v[78:79], v[38:39]
    v_pk_add_f32 v[32:33], v[32:33], v[80:81]
    v_pk_add_f32 v[34:35], v[34:35], v[82:83]
    v_pk_fma_f32 v[36:37], v[80:81], v[80:81], v[36:37]
    v_pk_fma_f32 v[38:39], v[82:83], v[82:83], v[38:39]
    v_pk_add_f32 v[32:33], v[32:33], v[84:85]
    v_pk_add_f32 v[34:35], v[34:35], v[86:87]
    v_pk_fma_f32 v[36:37], v[84:85], v[84:85], v[36:37]
    v_pk_fma_f32 v[38:39], v[86:87], v[86:87], v[38:39]
    s_nop 0
    v_permlane32_swap_b32 v32, v36
    v_permlane32_swap_b32 v33, v37
    v_permlane32_swap_b32 v34, v38
    v_permlane32_swap_b32 v35, v39
    v_pk_add_f32 v[32:33], v[32:33], v[36:37]
    v_pk_add_f32 v[34:35], v[34:35], v[38:39]
    s_nop 1
    v_permlane16_swap_b32 v32, v34
    v_permlane16_swap_b32 v33, v35
    v_pk_add_f32 v[32:33], v[32:33], v[34:35]
    s_nop 1
    v_add_f32_dpp v32, v32, v32 row_ror:8 row_mask:0xf bank_mask:0xf
    v_add_f32_dpp v33, v33, v33 row_ror:8 row_mask:0xf bank_mask:0xf
    s_nop 0
    v_add_f32_dpp v32, v32, v32 quad_perm:[1,0,3,2] row_mask:0xf bank_mask:0xf
    v_add_f32_dpp v33, v33, v33 quad_perm:[1,0,3,2] row_mask:0xf bank_mask:0xf
    s_nop 0
    v_add_f32_dpp v32, v32, v32 quad_perm:[2,3,0,1] row_mask:0xf bank_mask:0xf
    v_add_f32_dpp v33, v33, v33 quad_perm:[2,3,0,1] row_mask:0xf bank_mask:0xf
    s_mov_b64 exec, s[8:9]
    ds_add_f32 v4, v32 offset:128
    ds_add_f32 v4, v33 offset:132
    s_mov_b64 exec, -1
    ds_write_b64 v100, v[240:241]
    ds_write_b64 v101, v[242:243]
    ds_write_b64 v102, v[244:245]
    ds_write_b64 v103, v[246:247]
    s_waitcnt lgkmcnt(4)
    s_barrier
    ds_read_b128 v[88:91], v5 offset:128
    ds_read_b128 v[92:95], v5 offset:144
    s_waitcnt lgkmcnt(0)
    v_pk_mul_f32 v[88:89], v[88:89], v[106:107] op_sel_hi:[1,0]
    v_pk_mul_f32 v[90:91], v[90:91], v[106:107] op_sel_hi:[1,0]
    v_pk_fma_f32 v[92:93], v[92:93], v[106:107], v[106:107] op_sel:[0,0,1] op_sel_hi:[1,0,1]
    v_pk_fma_f32 v[94:95], v[94:95], v[106:107], v[106:107] op_sel:[0,0,1] op_sel_hi:[1,0,1]
    v_pk_fma_f32 v[92:93], v[88:89], v[88:89], v[92:93] neg_lo:[1,0,0] neg_hi:[1,0,0]
    v_pk_fma_f32 v[94:95], v[90:91], v[90:91], v[94:95] neg_lo:[1,0,0] neg_hi:[1,0,0]
    v_max_f32 v92, v107, v92
    v_max_f32 v93, v107, v93
    v_max_f32 v94, v107, v94
    v_max_f32 v95, v107, v95
    v_rsq_f32 v92, v92
    v_rsq_f32 v93, v93
    v_rsq_f32 v94, v94
    v_rsq_f32 v95, v95
    v_pk_mul_f32 v[88:89], v[88:89], v[92:93] neg_lo:[1,0] neg_hi:[1,0]
    v_pk_mul_f32 v[90:91], v[90:91], v[94:95] neg_lo:[1,0] neg_hi:[1,0]
    v_pk_fma_f32 v[72:73], v[72:73], v[92:93], v[88:89]
    v_pk_fma_f32 v[74:75], v[74:75], v[94:95], v[90:91]
    v_pk_fma_f32 v[76:77], v[76:77], v[92:93], v[88:89]
    v_pk_fma_f32 v[78:79], v[78:79], v[94:95], v[90:91]
    v_pk_fma_f32 v[80:81], v[80:81], v[92:93], v[88:89]
    v_pk_fma_f32 v[82:83], v[82:83], v[94:95], v[90:91]
    v_pk_fma_f32 v[84:85], v[84:85], v[92:93], v[88:89]
    v_pk_fma_f32 v[86:87], v[86:87], v[94:95], v[90:91]
    v_cvt_pk_bf16_f32 v40, v72, v76
    v_cvt_pk_bf16_f32 v41, v80, v84
    v_cvt_pk_bf16_f32 v42, v73, v77
    v_cvt_pk_bf16_f32 v43, v81, v85
    v_cvt_pk_bf16_f32 v44, v74, v78
    v_cvt_pk_bf16_f32 v45, v82, v86
    v_cvt_pk_bf16_f32 v46, v75, v79
    v_cvt_pk_bf16_f32 v47, v83, v87
    ds_write_b64 v100, v[40:41] offset:49152
    ds_write_b64 v101, v[42:43] offset:49152
    ds_write_b64 v102, v[44:45] offset:49152
    ds_write_b64 v103, v[46:47] offset:49152
    s_cmp_ge_u32 s52, 4
    s_cbranch_scc1 L_b2
    s_mov_b32 s3, 13631488
    s_waitcnt lgkmcnt(0)
    s_barrier
    ds_read_b128 v[64:67], v14 offset:49152
    ds_read_b128 v[68:71], v14 offset:53248
    ds_read_b128 v[72:75], v14 offset:57344
    ds_read_b128 v[76:79], v14 offset:61440
    s_waitcnt lgkmcnt(3)
    buffer_store_dwordx4 v[64:67], v15, s[36:39], s3 offen sc1
    s_add_u32 s3, s3, 0x100000
    s_waitcnt lgkmcnt(2)
    buffer_store_dwordx4 v[68:71], v15, s[36:39], s3 offen sc1
    s_add_u32 s3, s3, 0x100000
    s_waitcnt lgkmcnt(1)
    buffer_store_dwordx4 v[72:75], v15, s[36:39], s3 offen sc1
    s_add_u32 s3, s3, 0x100000
    s_waitcnt lgkmcnt(0)
    buffer_store_dwordx4 v[76:79], v15, s[36:39], s3 offen sc1
    s_lshl_b32 s3, s1, 2
    s_add_u32 s3, s3, s52
    s_lshl_b32 s3, s3, 7
    s_add_u32 s3, s3, 131072
    s_waitcnt vmcnt(0)
    v_mov_b32 v52, s53
    v_mov_b32 v53, s53
    v_mov_b32 v54, s53
    v_mov_b32 v55, s53
    s_mov_b64 exec, 0xff
    buffer_store_dwordx4 v[52:55], v11, s[36:39], s3 offen sc1
    s_mov_b64 exec, -1
    s_barrier
    s_and_b32 s64, s52, 1
    s_lshr_b32 s65, s52, 1
    v_lshrrev_b32 v3, 4, v2
    v_and_b32 v4, 15, v2
    v_lshrrev_b32 v6, 2, v2
    v_and_b32 v6, 7, v6
    v_lshrrev_b32 v7, 1, v6
    v_lshlrev_b32 v7, 5, v7
    v_lshl_add_u32 v7, v6, 7, v7
    v_and_b32 v8, 3, v2
    v_lshl_add_u32 v7, v8, 3, v7
    v_lshrrev_b32 v9, 5, v2
    v_lshl_add_u32 v7, v9, 10, v7
    s_and_b32 s57, s2, 7
    s_lshr_b32 s58, s2, 3
    s_lshr_b32 s60, s57, 1
    s_lshl_b32 s60, s60, 2
    s_and_b32 s3, s58, 3
    s_add_u32 s60, s60, s3
    s_and_b32 s61, s57, 1
    s_lshr_b32 s62, s58, 2
    s_lshl_b32 s62, s62, 8
    s_lshl_b32 s3, s61, 7
    s_add_u32 s62, s62, s3
    s_xor_b32 s63, s62, 128
    s_mov_b32 s40, s24
    s_mov_b32 s41, s25
    s_mov_b32 s42, 2048
    s_mov_b32 s43, 0x20000
    s_lshl_b32 s3, s65, 6
    s_add_u32 s3, s3, s62
    s_lshl_b32 s57, s3, 1
    s_add_u32 s57, s57, 86016
    v_lshlrev_b32 v6, 3, v3
    v_lshlrev_b32 v18, 4, v3
    buffer_load_dwordx2 v[224:225], v6, s[40:43], s3 offen offset:0
    buffer_load_dwordx2 v[226:227], v6, s[40:43], s3 offen offset:32
    buffer_load_dwordx4 v[228:231], v18, s[36:39], s57 offen offset:0 sc1
    buffer_load_dwordx4 v[232:235], v18, s[36:39], s57 offen offset:64 sc1
    s_and_b32 s57, s2, 7
    s_lshr_b32 s58, s2, 3
    s_and_b32 s60, s57, 1
    s_lshl_b32 s60, s60, 3
    s_and_b32 s3, s58, 7
    s_add_u32 s60, s60, s3
    s_lshr_b32 s61, s57, 1
    s_lshl_b32 s61, s61, 2
    s_lshr_b32 s3, s58, 3
    s_add_u32 s61, s61, s3
    s_mul_i32 s62, s61, 448
    s_and_b32 s3, s61, 1
    s_cmp_eq_u32 s3, 0
    s_cselect_b32 s63, 384, 0
    s_cselect_b32 s3, 0, 64
    s_add_u32 s63, s63, s62
    s_add_u32 s62, s62, s3
    s_lshl_b32 s3, s64, 13
    s_add_u32 s3, s3, 86016
    v_lshlrev_b32 v5, 4, v2
    v_add_u32 v5, s3, v5
    s_lshl_b32 s3, s65, 14
    v_xor_b32 v10, 0, v7
    v_add_u32 v10, s3, v10
    v_xor_b32 v11, 32, v7
    v_add_u32 v11, s3, v11
    v_xor_b32 v12, 64, v7
    v_add_u32 v12, s3, v12
    v_xor_b32 v13, 96, v7
    v_add_u32 v13, s3, v13
    s_lshl_b32 s3, s65, 6
    v_xor_b32 v14, s3, v7
    v_xor_b32 v14, 0, v14
    v_add_u32 v14, 8192, v14
    v_xor_b32 v15, s3, v7
    v_xor_b32 v15, 32, v15
    v_add_u32 v15, 8192, v15
    v_and_b32 v9, 2, v8
    v_or_b32 v9, s65, v9
    v_and_b32 v6, 1, v3
    v_xor_b32 v9, v9, v6
    v_lshlrev_b32 v9, 4, v9
    v_lshrrev_b32 v6, 2, v2
    v_lshl_add_u32 v9, v6, 6, v9
    v_and_b32 v6, 1, v8
    v_lshl_add_u32 v9, v6, 3, v9
    v_add_u32 v16, 24576, v9
    s_lshl_b32 s3, s65, 8
    s_add_u32 s44, s62, s3
    s_add_u32 s45, s44, 32
    s_add_u32 s46, s44, 64
    s_add_u32 s47, s44, 96
    s_lshl_b32 s3, s65, 6
    s_add_u32 s48, s62, s3
    s_add_u32 s48, s48, 128
    s_add_u32 s49, s48, 32
    s_lshl_b32 s3, s65, 4
    s_add_u32 s50, s63, s3
    s_mov_b32 s40, s20
    s_mov_b32 s41, s21
    s_mov_b32 s42, 7168
    s_mov_b32 s43, 0x20000
    v_lshlrev_b32 v6, 3, v3
    v_and_b32 v9, 1, v3
    v_lshlrev_b32 v9, 3, v9
    v_lshrrev_b32 v17, 1, v3
    v_lshl_add_u32 v9, v17, 5, v9
    buffer_load_dwordx2 v[192:193], v6, s[40:43], s44 offen
    buffer_load_dwordx2 v[194:195], v6, s[40:43], s45 offen
    buffer_load_dwordx2 v[196:197], v6, s[40:43], s46 offen
    buffer_load_dwordx2 v[198:199], v6, s[40:43], s47 offen
    buffer_load_dwordx2 v[200:201], v6, s[40:43], s48 offen
    buffer_load_dwordx2 v[202:203], v6, s[40:43], s49 offen
    buffer_load_dwordx2 v[204:205], v9, s[40:43], s50 offen
    s_waitcnt vmcnt(0)
    v_lshlrev_b32 v20, 16, v192
    v_and_b32 v21, 0xffff0000, v192
    v_lshlrev_b32 v22, 16, v193
    v_and_b32 v23, 0xffff0000, v193
    v_lshlrev_b32 v24, 16, v194
    v_and_b32 v25, 0xffff0000, v194
    v_lshlrev_b32 v26, 16, v195
    v_and_b32 v27, 0xffff0000, v195
    v_lshlrev_b32 v28, 16, v196
    v_and_b32 v29, 0xffff0000, v196
    v_lshlrev_b32 v30, 16, v197
    v_and_b32 v31, 0xffff0000, v197
    v_lshlrev_b32 v32, 16, v198
    v_and_b32 v33, 0xffff0000, v198
    v_lshlrev_b32 v34, 16, v199
    v_and_b32 v35, 0xffff0000, v199
    v_lshlrev_b32 v36, 16, v200
    v_and_b32 v37, 0xffff0000, v200
    v_lshlrev_b32 v38, 16, v201
    v_and_b32 v39, 0xffff0000, v201
    v_lshlrev_b32 v40, 16, v202
    v_and_b32 v41, 0xffff0000, v202
    v_lshlrev_b32 v42, 16, v203
    v_and_b32 v43, 0xffff0000, v203
    v_lshlrev_b32 v44, 16, v204
    v_and_b32 v45, 0xffff0000, v204
    v_lshlrev_b32 v46, 16, v205
    v_and_b32 v47, 0xffff0000, v205
    v_mov_b32 v48, v20
    v_mov_b32 v49, v21
    v_mov_b32 v50, v22
    v_mov_b32 v51, v23
    v_mov_b32 v52, v24
    v_mov_b32 v53, v25
    v_mov_b32 v54, v26
    v_mov_b32 v55, v27
    v_mov_b32 v56, v28
    v_mov_b32 v57, v29
    v_mov_b32 v58, v30
    v_mov_b32 v59, v31
    v_mov_b32 v60, v32
    v_mov_b32 v61, v33
    v_mov_b32 v62, v34
    v_mov_b32 v63, v35
    v_mov_b32 v64, v36
    v_mov_b32 v65, v37
    v_mov_b32 v66, v38
    v_mov_b32 v67, v39
    v_mov_b32 v68, v40
    v_mov_b32 v69, v41
    v_mov_b32 v70, v42
    v_mov_b32 v71, v43
    v_mov_b32 v72, v44
    v_mov_b32 v73, v45
    v_mov_b32 v74, v46
    v_mov_b32 v75, v47
    v_mov_b32 v76, v20
    v_mov_b32 v77, v21
    v_mov_b32 v78, v22
    v_mov_b32 v79, v23
    v_mov_b32 v80, v24
    v_mov_b32 v81, v25
    v_mov_b32 v82, v26
    v_mov_b32 v83, v27
    v_mov_b32 v84, v28
    v_mov_b32 v85, v29
    v_mov_b32 v86, v30
    v_mov_b32 v87, v31
    v_mov_b32 v88, v32
    v_mov_b32 v89, v33
    v_mov_b32 v90, v34
    v_mov_b32 v91, v35
    v_mov_b32 v92, v36
    v_mov_b32 v93, v37
    v_mov_b32 v94, v38
    v_mov_b32 v95, v39
    v_mov_b32 v96, v40
    v_mov_b32 v97, v41
    v_mov_b32 v98, v42
    v_mov_b32 v99, v43
    v_mov_b32 v100, v44
    v_mov_b32 v101, v45
    v_mov_b32 v102, v46
    v_mov_b32 v103, v47
    v_mov_b32 v104, v20
    v_mov_b32 v105, v21
    v_mov_b32 v106, v22
    v_mov_b32 v107, v23
    v_mov_b32 v108, v24
    v_mov_b32 v109, v25
    v_mov_b32 v110, v26
    v_mov_b32 v111, v27
    v_mov_b32 v112, v28
    v_mov_b32 v113, v29
    v_mov_b32 v114, v30
    v_mov_b32 v115, v31
    v_mov_b32 v116, v32
    v_mov_b32 v117, v33
    v_mov_b32 v118, v34
    v_mov_b32 v119, v35
    v_mov_b32 v120, v36
    v_mov_b32 v121, v37
    v_mov_b32 v122, v38
    v_mov_b32 v123, v39
    v_mov_b32 v124, v40
    v_mov_b32 v125, v41
    v_mov_b32 v126, v42
    v_mov_b32 v127, v43
    v_mov_b32 v128, v44
    v_mov_b32 v129, v45
    v_mov_b32 v130, v46
    v_mov_b32 v131, v47
    v_mov_b32 v240, 0xbdd2d3e8
    v_mov_b32 v241, v240
    v_mov_b32 v242, 0xc0135761
    v_mov_b32 v243, v242
    s_lshl_b32 s3, s60, 3
    s_lshl_b32 s57, s64, 2
    s_add_u32 s3, s3, s57
    s_lshl_b32 s3, s3, 11
    s_add_u32 s3, s3, 17825792
    v_lshlrev_b32 v9, 4, v2
    v_add_u32 v7, s3, v9
    v_lshrrev_b32 v8, 5, v2
    v_mul_u32_u24 v8, 1536, v8
    v_add_u32 v8, v8, v7
    s_lshl_b32 s3, s65, 9
    v_add_u32 v8, s3, v8
    s_lshr_b32 s44, s62, 7
    s_add_u32 s48, s44, 1
    s_lshl_b32 s3, s65, 1
    s_add_u32 s44, s44, s3
    s_lshl_b32 s44, s44, 18
    s_add_u32 s46, s44, 1024
    s_lshl_b32 s48, s48, 18
    s_lshl_b32 s3, s65, 10
    s_add_u32 s48, s48, s3
    s_and_b32 s3, s63, 64
    s_lshl_b32 s3, s3, 4
    s_lshr_b32 s50, s63, 7
    s_lshl_b32 s50, s50, 18
    s_add_u32 s50, s50, s3
    s_lshl_b32 s45, s60, 4
    s_add_u32 s45, s45, s61
    s_lshl_b32 s45, s45, 2
    s_add_u32 s45, s45, s52
    s_lshl_b32 s45, s45, 7
    s_mov_b32 s59, 15
    s_mov_b32 s58, 1
    s_mov_b32 s66, 16384
    s_mov_b32 s67, 28672
    s_mov_b32 s70, 4294934528
    s_mov_b32 s71, 4294909952
    s_mov_b32 s68, s66
    s_mov_b32 s69, s67
    s_barrier
    ds_read_b128 v[132:135], v5 offset:0
    ds_read_b128 v[136:139], v5 offset:2048
    ds_read_b128 v[140:143], v5 offset:4096
    ds_read_b128 v[144:147], v5 offset:6144
    ds_read_b64_tr_b16 v[164:165], v10 offset:0
    ds_read_b64_tr_b16 v[166:167], v10 offset:2048
    ds_read_b64_tr_b16 v[168:169], v11 offset:0
    ds_read_b64_tr_b16 v[170:171], v11 offset:2048
    ds_read_b64_tr_b16 v[172:173], v12 offset:0
    ds_read_b64_tr_b16 v[174:175], v12 offset:2048
    ds_read_b64_tr_b16 v[176:177], v13 offset:0
    ds_read_b64_tr_b16 v[178:179], v13 offset:2048
    ds_read_b64_tr_b16 v[180:181], v14 offset:0
    ds_read_b64_tr_b16 v[182:183], v14 offset:2048
    ds_read_b64_tr_b16 v[184:185], v15 offset:0
    ds_read_b64_tr_b16 v[186:187], v15 offset:2048
    ds_read_b64_tr_b16 v[188:189], v16 offset:0
    ds_read_b64_tr_b16 v[190:191], v16 offset:1024
    s_waitcnt lgkmcnt(0)
.p2align 3
cloop_9:
    v_mfma_f32_16x16x32_bf16 v[20:23], v[164:167], v[132:135], v[20:23]
    ds_read_b128 v[148:151], v5 offset:1024
    v_mfma_f32_16x16x32_bf16 v[24:27], v[168:171], v[132:135], v[24:27]
    ds_read_b128 v[152:155], v5 offset:3072
    v_mfma_f32_16x16x32_bf16 v[28:31], v[172:175], v[132:135], v[28:31]
    ds_read_b128 v[156:159], v5 offset:5120
    v_mfma_f32_16x16x32_bf16 v[32:35], v[176:179], v[132:135], v[32:35]
    ds_read_b128 v[160:163], v5 offset:7168
    v_mfma_f32_16x16x32_bf16 v[36:39], v[180:183], v[132:135], v[36:39]
    ds_read_b64_tr_b16 v[192:193], v10 offset:4096
    v_mfma_f32_16x16x32_bf16 v[40:43], v[184:187], v[132:135], v[40:43]
    ds_read_b64_tr_b16 v[194:195], v10 offset:6144
    v_mfma_f32_16x16x32_bf16 v[44:47], v[188:191], v[132:135], v[44:47]
    ds_read_b64_tr_b16 v[196:197], v11 offset:4096
    v_mfma_f32_16x16x32_bf16 v[48:51], v[164:167], v[136:139], v[48:51]
    ds_read_b64_tr_b16 v[198:199], v11 offset:6144
    v_mfma_f32_16x16x32_bf16 v[52:55], v[168:171], v[136:139], v[52:55]
    ds_read_b64_tr_b16 v[200:201], v12 offset:4096
    v_mfma_f32_16x16x32_bf16 v[56:59], v[172:175], v[136:139], v[56:59]
    ds_read_b64_tr_b16 v[202:203], v12 offset:6144
    v_mfma_f32_16x16x32_bf16 v[60:63], v[176:179], v[136:139], v[60:63]
    ds_read_b64_tr_b16 v[204:205], v13 offset:4096
    v_mfma_f32_16x16x32_bf16 v[64:67], v[180:183], v[136:139], v[64:67]
    ds_read_b64_tr_b16 v[206:207], v13 offset:6144
    v_mfma_f32_16x16x32_bf16 v[68:71], v[184:187], v[136:139], v[68:71]
    ds_read_b64_tr_b16 v[208:209], v14 offset:4096
    v_mfma_f32_16x16x32_bf16 v[72:75], v[188:191], v[136:139], v[72:75]
    ds_read_b64_tr_b16 v[210:211], v14 offset:6144
    v_mfma_f32_16x16x32_bf16 v[76:79], v[164:167], v[140:143], v[76:79]
    ds_read_b64_tr_b16 v[212:213], v15 offset:4096
    v_mfma_f32_16x16x32_bf16 v[80:83], v[168:171], v[140:143], v[80:83]
    ds_read_b64_tr_b16 v[214:215], v15 offset:6144
    v_mfma_f32_16x16x32_bf16 v[84:87], v[172:175], v[140:143], v[84:87]
    ds_read_b64_tr_b16 v[216:217], v16 offset:2048
    v_mfma_f32_16x16x32_bf16 v[88:91], v[176:179], v[140:143], v[88:91]
    ds_read_b64_tr_b16 v[218:219], v16 offset:3072
    v_mfma_f32_16x16x32_bf16 v[92:95], v[180:183], v[140:143], v[92:95]
    v_add_u32 v5, s68, v5
    v_add_u32 v10, s69, v10
    v_mfma_f32_16x16x32_bf16 v[96:99], v[184:187], v[140:143], v[96:99]
    v_add_u32 v11, s69, v11
    v_add_u32 v12, s69, v12
    v_mfma_f32_16x16x32_bf16 v[100:103], v[188:191], v[140:143], v[100:103]
    v_add_u32 v13, s69, v13
    v_add_u32 v14, s69, v14
    v_mfma_f32_16x16x32_bf16 v[104:107], v[164:167], v[144:147], v[104:107]
    v_add_u32 v15, s69, v15
    v_add_u32 v16, s69, v16
    v_mfma_f32_16x16x32_bf16 v[108:111], v[168:171], v[144:147], v[108:111]
    v_mfma_f32_16x16x32_bf16 v[112:115], v[172:175], v[144:147], v[112:115]
    v_mfma_f32_16x16x32_bf16 v[116:119], v[176:179], v[144:147], v[116:119]
    v_mfma_f32_16x16x32_bf16 v[120:123], v[180:183], v[144:147], v[120:123]
    s_waitcnt lgkmcnt(0)
    s_barrier
    v_mfma_f32_16x16x32_bf16 v[124:127], v[184:187], v[144:147], v[124:127]
    v_mfma_f32_16x16x32_bf16 v[128:131], v[188:191], v[144:147], v[128:131]
    v_mfma_f32_16x16x32_bf16 v[20:23], v[192:195], v[148:151], v[20:23]
    ds_read_b128 v[132:135], v5 offset:0
    v_mfma_f32_16x16x32_bf16 v[24:27], v[196:199], v[148:151], v[24:27]
    ds_read_b128 v[136:139], v5 offset:2048
    v_mfma_f32_16x16x32_bf16 v[28:31], v[200:203], v[148:151], v[28:31]
    ds_read_b128 v[140:143], v5 offset:4096
    v_mfma_f32_16x16x32_bf16 v[32:35], v[204:207], v[148:151], v[32:35]
    ds_read_b128 v[144:147], v5 offset:6144
    v_mfma_f32_16x16x32_bf16 v[36:39], v[208:211], v[148:151], v[36:39]
    ds_read_b64_tr_b16 v[164:165], v10 offset:0
    v_mfma_f32_16x16x32_bf16 v[40:43], v[212:215], v[148:151], v[40:43]
    ds_read_b64_tr_b16 v[166:167], v10 offset:2048
    v_mfma_f32_16x16x32_bf16 v[44:47], v[216:219], v[148:151], v[44:47]
    ds_read_b64_tr_b16 v[168:169], v11 offset:0
    v_mfma_f32_16x16x32_bf16 v[48:51], v[192:195], v[152:155], v[48:51]
    ds_read_b64_tr_b16 v[170:171], v11 offset:2048
    v_mfma_f32_16x16x32_bf16 v[52:55], v[196:199], v[152:155], v[52:55]
    ds_read_b64_tr_b16 v[172:173], v12 offset:0
    v_mfma_f32_16x16x32_bf16 v[56:59], v[200:203], v[152:155], v[56:59]
    ds_read_b64_tr_b16 v[174:175], v12 offset:2048
    v_mfma_f32_16x16x32_bf16 v[60:63], v[204:207], v[152:155], v[60:63]
    ds_read_b64_tr_b16 v[176:177], v13 offset:0
    v_mfma_f32_16x16x32_bf16 v[64:67], v[208:211], v[152:155], v[64:67]
    ds_read_b64_tr_b16 v[178:179], v13 offset:2048
    v_mfma_f32_16x16x32_bf16 v[68:71], v[212:215], v[152:155], v[68:71]
    ds_read_b64_tr_b16 v[180:181], v14 offset:0
    v_mfma_f32_16x16x32_bf16 v[72:75], v[216:219], v[152:155], v[72:75]
    ds_read_b64_tr_b16 v[182:183], v14 offset:2048
    v_mfma_f32_16x16x32_bf16 v[76:79], v[192:195], v[156:159], v[76:79]
    ds_read_b64_tr_b16 v[184:185], v15 offset:0
    v_mfma_f32_16x16x32_bf16 v[80:83], v[196:199], v[156:159], v[80:83]
    ds_read_b64_tr_b16 v[186:187], v15 offset:2048
    v_mfma_f32_16x16x32_bf16 v[84:87], v[200:203], v[156:159], v[84:87]
    ds_read_b64_tr_b16 v[188:189], v16 offset:0
    v_mfma_f32_16x16x32_bf16 v[88:91], v[204:207], v[156:159], v[88:91]
    ds_read_b64_tr_b16 v[190:191], v16 offset:1024
    v_mfma_f32_16x16x32_bf16 v[92:95], v[208:211], v[156:159], v[92:95]
    s_add_u32 s58, s58, 1
    s_cmp_eq_u32 s58, 3
    v_mfma_f32_16x16x32_bf16 v[96:99], v[212:215], v[156:159], v[96:99]
    s_cselect_b32 s58, 0, s58
    s_cselect_b32 s68, s70, s66
    v_mfma_f32_16x16x32_bf16 v[100:103], v[216:219], v[156:159], v[100:103]
    s_cselect_b32 s69, s71, s67
    s_sub_u32 s59, s59, 1
    v_mfma_f32_16x16x32_bf16 v[104:107], v[192:195], v[160:163], v[104:107]
    v_mfma_f32_16x16x32_bf16 v[108:111], v[196:199], v[160:163], v[108:111]
    v_mfma_f32_16x16x32_bf16 v[112:115], v[200:203], v[160:163], v[112:115]
    v_mfma_f32_16x16x32_bf16 v[116:119], v[204:207], v[160:163], v[116:119]
    v_mfma_f32_16x16x32_bf16 v[120:123], v[208:211], v[160:163], v[120:123]
    v_mfma_f32_16x16x32_bf16 v[124:127], v[212:215], v[160:163], v[124:127]
    s_waitcnt lgkmcnt(0)
    s_nop 0
    v_mfma_f32_16x16x32_bf16 v[128:131], v[216:219], v[160:163], v[128:131]
    s_cbranch_scc0 cloop_9
    v_pk_mul_f32 v[132:133], v[36:37], v[36:37]
    v_pk_mul_f32 v[134:135], v[38:39], v[38:39]
    v_pk_mul_f32 v[136:137], v[40:41], v[40:41]
    v_pk_mul_f32 v[138:139], v[42:43], v[42:43]
    v_pk_fma_f32 v[132:133], v[132:133], v[240:241], v[242:243]
    v_pk_fma_f32 v[134:135], v[134:135], v[240:241], v[242:243]
    v_pk_fma_f32 v[136:137], v[136:137], v[240:241], v[242:243]
    v_pk_fma_f32 v[138:139], v[138:139], v[240:241], v[242:243]
    v_pk_mul_f32 v[132:133], v[132:133], v[36:37]
    v_pk_mul_f32 v[134:135], v[134:135], v[38:39]
    v_pk_mul_f32 v[136:137], v[136:137], v[40:41]
    v_pk_mul_f32 v[138:139], v[138:139], v[42:43]
    v_exp_f32 v132, v132
    v_exp_f32 v133, v133
    v_exp_f32 v134, v134
    v_exp_f32 v135, v135
    v_exp_f32 v136, v136
    v_exp_f32 v137, v137
    v_exp_f32 v138, v138
    v_exp_f32 v139, v139
    v_pk_add_f32 v[132:133], v[132:133], 1.0 op_sel_hi:[1,0]
    v_pk_add_f32 v[134:135], v[134:135], 1.0 op_sel_hi:[1,0]
    v_pk_add_f32 v[136:137], v[136:137], 1.0 op_sel_hi:[1,0]
    v_pk_add_f32 v[138:139], v[138:139], 1.0 op_sel_hi:[1,0]
    v_rcp_f32 v132, v132
    v_rcp_f32 v133, v133
    v_rcp_f32 v134, v134
    v_rcp_f32 v135, v135
    v_rcp_f32 v136, v136
    v_rcp_f32 v137, v137
    v_rcp_f32 v138, v138
    v_rcp_f32 v139, v139
    v_pk_mul_f32 v[132:133], v[132:133], v[36:37]
    v_pk_mul_f32 v[134:135], v[134:135], v[38:39]
    v_pk_mul_f32 v[136:137], v[136:137], v[40:41]
    v_pk_mul_f32 v[138:139], v[138:139], v[42:43]
    v_cvt_pk_bf16_f32 v148, v132, v133
    v_cvt_pk_bf16_f32 v149, v134, v135
    v_cvt_pk_bf16_f32 v150, v136, v137
    v_cvt_pk_bf16_f32 v151, v138, v139
    s_add_u32 s3, s48, 0
    buffer_store_dwordx4 v[148:151], v7, s[36:39], s3 offen sc1
    v_pk_mul_f32 v[132:133], v[64:65], v[64:65]
    v_pk_mul_f32 v[134:135], v[66:67], v[66:67]
    v_pk_mul_f32 v[136:137], v[68:69], v[68:69]
    v_pk_mul_f32 v[138:139], v[70:71], v[70:71]
    v_pk_fma_f32 v[132:133], v[132:133], v[240:241], v[242:243]
    v_pk_fma_f32 v[134:135], v[134:135], v[240:241], v[242:243]
    v_pk_fma_f32 v[136:137], v[136:137], v[240:241], v[242:243]
    v_pk_fma_f32 v[138:139], v[138:139], v[240:241], v[242:243]
    v_pk_mul_f32 v[132:133], v[132:133], v[64:65]
    v_pk_mul_f32 v[134:135], v[134:135], v[66:67]
    v_pk_mul_f32 v[136:137], v[136:137], v[68:69]
    v_pk_mul_f32 v[138:139], v[138:139], v[70:71]
    v_exp_f32 v132, v132
    v_exp_f32 v133, v133
    v_exp_f32 v134, v134
    v_exp_f32 v135, v135
    v_exp_f32 v136, v136
    v_exp_f32 v137, v137
    v_exp_f32 v138, v138
    v_exp_f32 v139, v139
    v_pk_add_f32 v[132:133], v[132:133], 1.0 op_sel_hi:[1,0]
    v_pk_add_f32 v[134:135], v[134:135], 1.0 op_sel_hi:[1,0]
    v_pk_add_f32 v[136:137], v[136:137], 1.0 op_sel_hi:[1,0]
    v_pk_add_f32 v[138:139], v[138:139], 1.0 op_sel_hi:[1,0]
    v_rcp_f32 v132, v132
    v_rcp_f32 v133, v133
    v_rcp_f32 v134, v134
    v_rcp_f32 v135, v135
    v_rcp_f32 v136, v136
    v_rcp_f32 v137, v137
    v_rcp_f32 v138, v138
    v_rcp_f32 v139, v139
    v_pk_mul_f32 v[132:133], v[132:133], v[64:65]
    v_pk_mul_f32 v[134:135], v[134:135], v[66:67]
    v_pk_mul_f32 v[136:137], v[136:137], v[68:69]
    v_pk_mul_f32 v[138:139], v[138:139], v[70:71]
    v_cvt_pk_bf16_f32 v152, v132, v133
    v_cvt_pk_bf16_f32 v153, v134, v135
    v_cvt_pk_bf16_f32 v154, v136, v137
    v_cvt_pk_bf16_f32 v155, v138, v139
    s_add_u32 s3, s48, 2048
    buffer_store_dwordx4 v[152:155], v7, s[36:39], s3 offen sc1
    v_pk_mul_f32 v[132:133], v[92:93], v[92:93]
    v_pk_mul_f32 v[134:135], v[94:95], v[94:95]
    v_pk_mul_f32 v[136:137], v[96:97], v[96:97]
    v_pk_mul_f32 v[138:139], v[98:99], v[98:99]
    v_pk_fma_f32 v[132:133], v[132:133], v[240:241], v[242:243]
    v_pk_fma_f32 v[134:135], v[134:135], v[240:241], v[242:243]
    v_pk_fma_f32 v[136:137], v[136:137], v[240:241], v[242:243]
    v_pk_fma_f32 v[138:139], v[138:139], v[240:241], v[242:243]
    v_pk_mul_f32 v[132:133], v[132:133], v[92:93]
    v_pk_mul_f32 v[134:135], v[134:135], v[94:95]
    v_pk_mul_f32 v[136:137], v[136:137], v[96:97]
    v_pk_mul_f32 v[138:139], v[138:139], v[98:99]
    v_exp_f32 v132, v132
    v_exp_f32 v133, v133
    v_exp_f32 v134, v134
    v_exp_f32 v135, v135
    v_exp_f32 v136, v136
    v_exp_f32 v137, v137
    v_exp_f32 v138, v138
    v_exp_f32 v139, v139
    v_pk_add_f32 v[132:133], v[132:133], 1.0 op_sel_hi:[1,0]
    v_pk_add_f32 v[134:135], v[134:135], 1.0 op_sel_hi:[1,0]
    v_pk_add_f32 v[136:137], v[136:137], 1.0 op_sel_hi:[1,0]
    v_pk_add_f32 v[138:139], v[138:139], 1.0 op_sel_hi:[1,0]
    v_rcp_f32 v132, v132
    v_rcp_f32 v133, v133
    v_rcp_f32 v134, v134
    v_rcp_f32 v135, v135
    v_rcp_f32 v136, v136
    v_rcp_f32 v137, v137
    v_rcp_f32 v138, v138
    v_rcp_f32 v139, v139
    v_pk_mul_f32 v[132:133], v[132:133], v[92:93]
    v_pk_mul_f32 v[134:135], v[134:135], v[94:95]
    v_pk_mul_f32 v[136:137], v[136:137], v[96:97]
    v_pk_mul_f32 v[138:139], v[138:139], v[98:99]
    v_cvt_pk_bf16_f32 v156, v132, v133
    v_cvt_pk_bf16_f32 v157, v134, v135
    v_cvt_pk_bf16_f32 v158, v136, v137
    v_cvt_pk_bf16_f32 v159, v138, v139
    s_add_u32 s3, s48, 4096
    buffer_store_dwordx4 v[156:159], v7, s[36:39], s3 offen sc1
    v_pk_mul_f32 v[132:133], v[120:121], v[120:121]
    v_pk_mul_f32 v[134:135], v[122:123], v[122:123]
    v_pk_mul_f32 v[136:137], v[124:125], v[124:125]
    v_pk_mul_f32 v[138:139], v[126:127], v[126:127]
    v_pk_fma_f32 v[132:133], v[132:133], v[240:241], v[242:243]
    v_pk_fma_f32 v[134:135], v[134:135], v[240:241], v[242:243]
    v_pk_fma_f32 v[136:137], v[136:137], v[240:241], v[242:243]
    v_pk_fma_f32 v[138:139], v[138:139], v[240:241], v[242:243]
    v_pk_mul_f32 v[132:133], v[132:133], v[120:121]
    v_pk_mul_f32 v[134:135], v[134:135], v[122:123]
    v_pk_mul_f32 v[136:137], v[136:137], v[124:125]
    v_pk_mul_f32 v[138:139], v[138:139], v[126:127]
    v_exp_f32 v132, v132
    v_exp_f32 v133, v133
    v_exp_f32 v134, v134
    v_exp_f32 v135, v135
    v_exp_f32 v136, v136
    v_exp_f32 v137, v137
    v_exp_f32 v138, v138
    v_exp_f32 v139, v139
    v_pk_add_f32 v[132:133], v[132:133], 1.0 op_sel_hi:[1,0]
    v_pk_add_f32 v[134:135], v[134:135], 1.0 op_sel_hi:[1,0]
    v_pk_add_f32 v[136:137], v[136:137], 1.0 op_sel_hi:[1,0]
    v_pk_add_f32 v[138:139], v[138:139], 1.0 op_sel_hi:[1,0]
    v_rcp_f32 v132, v132
    v_rcp_f32 v133, v133
    v_rcp_f32 v134, v134
    v_rcp_f32 v135, v135
    v_rcp_f32 v136, v136
    v_rcp_f32 v137, v137
    v_rcp_f32 v138, v138
    v_rcp_f32 v139, v139
    v_pk_mul_f32 v[132:133], v[132:133], v[120:121]
    v_pk_mul_f32 v[134:135], v[134:135], v[122:123]
    v_pk_mul_f32 v[136:137], v[136:137], v[124:125]
    v_pk_mul_f32 v[138:139], v[138:139], v[126:127]
    v_cvt_pk_bf16_f32 v160, v132, v133
    v_cvt_pk_bf16_f32 v161, v134, v135
    v_cvt_pk_bf16_f32 v162, v136, v137
    v_cvt_pk_bf16_f32 v163, v138, v139
    s_add_u32 s3, s48, 6144
    buffer_store_dwordx4 v[160:163], v7, s[36:39], s3 offen sc1
    s_add_u32 s66, s45, 262144
    s_add_u32 s67, s45, 524288
    s_add_u32 s51, s45, 41943040
    v_pk_mul_f32 v[132:133], v[20:21], v[20:21]
    v_pk_mul_f32 v[134:135], v[22:23], v[22:23]
    v_pk_mul_f32 v[136:137], v[24:25], v[24:25]
    v_pk_mul_f32 v[138:139], v[26:27], v[26:27]
    v_pk_fma_f32 v[132:133], v[132:133], v[240:241], v[242:243]
    v_pk_fma_f32 v[134:135], v[134:135], v[240:241], v[242:243]
    v_pk_fma_f32 v[136:137], v[136:137], v[240:241], v[242:243]
    v_pk_fma_f32 v[138:139], v[138:139], v[240:241], v[242:243]
    v_pk_mul_f32 v[132:133], v[132:133], v[20:21]
    v_pk_mul_f32 v[134:135], v[134:135], v[22:23]
    v_pk_mul_f32 v[136:137], v[136:137], v[24:25]
    v_pk_mul_f32 v[138:139], v[138:139], v[26:27]
    v_exp_f32 v132, v132
    v_exp_f32 v133, v133
    v_exp_f32 v134, v134
    v_exp_f32 v135, v135
    v_exp_f32 v136, v136
    v_exp_f32 v137, v137
    v_exp_f32 v138, v138
    v_exp_f32 v139, v139
    v_pk_add_f32 v[132:133], v[132:133], 1.0 op_sel_hi:[1,0]
    v_pk_add_f32 v[134:135], v[134:135], 1.0 op_sel_hi:[1,0]
    v_pk_add_f32 v[136:137], v[136:137], 1.0 op_sel_hi:[1,0]
    v_pk_add_f32 v[138:139], v[138:139], 1.0 op_sel_hi:[1,0]
    v_rcp_f32 v132, v132
    v_rcp_f32 v133, v133
    v_rcp_f32 v134, v134
    v_rcp_f32 v135, v135
    v_rcp_f32 v136, v136
    v_rcp_f32 v137, v137
    v_rcp_f32 v138, v138
    v_rcp_f32 v139, v139
    v_pk_mul_f32 v[132:133], v[132:133], v[20:21]
    v_pk_mul_f32 v[134:135], v[134:135], v[22:23]
    v_pk_mul_f32 v[136:137], v[136:137], v[24:25]
    v_pk_mul_f32 v[138:139], v[138:139], v[26:27]
    v_cvt_pk_bf16_f32 v180, v132, v133
    v_cvt_pk_bf16_f32 v181, v134, v135
    v_cvt_pk_bf16_f32 v182, v136, v137
    v_cvt_pk_bf16_f32 v183, v138, v139
    v_pk_mul_f32 v[132:133], v[48:49], v[48:49]
    v_pk_mul_f32 v[134:135], v[50:51], v[50:51]
    v_pk_mul_f32 v[136:137], v[52:53], v[52:53]
    v_pk_mul_f32 v[138:139], v[54:55], v[54:55]
    v_pk_fma_f32 v[132:133], v[132:133], v[240:241], v[242:243]
    v_pk_fma_f32 v[134:135], v[134:135], v[240:241], v[242:243]
    v_pk_fma_f32 v[136:137], v[136:137], v[240:241], v[242:243]
    v_pk_fma_f32 v[138:139], v[138:139], v[240:241], v[242:243]
    v_pk_mul_f32 v[132:133], v[132:133], v[48:49]
    v_pk_mul_f32 v[134:135], v[134:135], v[50:51]
    v_pk_mul_f32 v[136:137], v[136:137], v[52:53]
    v_pk_mul_f32 v[138:139], v[138:139], v[54:55]
    v_exp_f32 v132, v132
    v_exp_f32 v133, v133
    v_exp_f32 v134, v134
    v_exp_f32 v135, v135
    v_exp_f32 v136, v136
    v_exp_f32 v137, v137
    v_exp_f32 v138, v138
    v_exp_f32 v139, v139
    v_pk_add_f32 v[132:133], v[132:133], 1.0 op_sel_hi:[1,0]
    v_pk_add_f32 v[134:135], v[134:135], 1.0 op_sel_hi:[1,0]
    v_pk_add_f32 v[136:137], v[136:137], 1.0 op_sel_hi:[1,0]
    v_pk_add_f32 v[138:139], v[138:139], 1.0 op_sel_hi:[1,0]
    v_rcp_f32 v132, v132
    v_rcp_f32 v133, v133
    v_rcp_f32 v134, v134
    v_rcp_f32 v135, v135
    v_rcp_f32 v136, v136
    v_rcp_f32 v137, v137
    v_rcp_f32 v138, v138
    v_rcp_f32 v139, v139
    v_pk_mul_f32 v[132:133], v[132:133], v[48:49]
    v_pk_mul_f32 v[134:135], v[134:135], v[50:51]
    v_pk_mul_f32 v[136:137], v[136:137], v[52:53]
    v_pk_mul_f32 v[138:139], v[138:139], v[54:55]
    v_cvt_pk_bf16_f32 v184, v132, v133
    v_cvt_pk_bf16_f32 v185, v134, v135
    v_cvt_pk_bf16_f32 v186, v136, v137
    v_cvt_pk_bf16_f32 v187, v138, v139
    v_pk_mul_f32 v[132:133], v[76:77], v[76:77]
    v_pk_mul_f32 v[134:135], v[78:79], v[78:79]
    v_pk_mul_f32 v[136:137], v[80:81], v[80:81]
    v_pk_mul_f32 v[138:139], v[82:83], v[82:83]
    v_pk_fma_f32 v[132:133], v[132:133], v[240:241], v[242:243]
    v_pk_fma_f32 v[134:135], v[134:135], v[240:241], v[242:243]
    v_pk_fma_f32 v[136:137], v[136:137], v[240:241], v[242:243]
    v_pk_fma_f32 v[138:139], v[138:139], v[240:241], v[242:243]
    v_pk_mul_f32 v[132:133], v[132:133], v[76:77]
    v_pk_mul_f32 v[134:135], v[134:135], v[78:79]
    v_pk_mul_f32 v[136:137], v[136:137], v[80:81]
    v_pk_mul_f32 v[138:139], v[138:139], v[82:83]
    v_exp_f32 v132, v132
    v_exp_f32 v133, v133
    v_exp_f32 v134, v134
    v_exp_f32 v135, v135
    v_exp_f32 v136, v136
    v_exp_f32 v137, v137
    v_exp_f32 v138, v138
    v_exp_f32 v139, v139
    v_pk_add_f32 v[132:133], v[132:133], 1.0 op_sel_hi:[1,0]
    v_pk_add_f32 v[134:135], v[134:135], 1.0 op_sel_hi:[1,0]
    v_pk_add_f32 v[136:137], v[136:137], 1.0 op_sel_hi:[1,0]
    v_pk_add_f32 v[138:139], v[138:139], 1.0 op_sel_hi:[1,0]
    v_rcp_f32 v132, v132
    v_rcp_f32 v133, v133
    v_rcp_f32 v134, v134
    v_rcp_f32 v135, v135
    v_rcp_f32 v136, v136
    v_rcp_f32 v137, v137
    v_rcp_f32 v138, v138
    v_rcp_f32 v139, v139
    v_pk_mul_f32 v[132:133], v[132:133], v[76:77]
    v_pk_mul_f32 v[134:135], v[134:135], v[78:79]
    v_pk_mul_f32 v[136:137], v[136:137], v[80:81]
    v_pk_mul_f32 v[138:139], v[138:139], v[82:83]
    v_cvt_pk_bf16_f32 v188, v132, v133
    v_cvt_pk_bf16_f32 v189, v134, v135
    v_cvt_pk_bf16_f32 v190, v136, v137
    v_cvt_pk_bf16_f32 v191, v138, v139
    v_pk_mul_f32 v[132:133], v[104:105], v[104:105]
    v_pk_mul_f32 v[134:135], v[106:107], v[106:107]
    v_pk_mul_f32 v[136:137], v[108:109], v[108:109]
    v_pk_mul_f32 v[138:139], v[110:111], v[110:111]
    v_pk_fma_f32 v[132:133], v[132:133], v[240:241], v[242:243]
    v_pk_fma_f32 v[134:135], v[134:135], v[240:241], v[242:243]
    v_pk_fma_f32 v[136:137], v[136:137], v[240:241], v[242:243]
    v_pk_fma_f32 v[138:139], v[138:139], v[240:241], v[242:243]
    v_pk_mul_f32 v[132:133], v[132:133], v[104:105]
    v_pk_mul_f32 v[134:135], v[134:135], v[106:107]
    v_pk_mul_f32 v[136:137], v[136:137], v[108:109]
    v_pk_mul_f32 v[138:139], v[138:139], v[110:111]
    v_exp_f32 v132, v132
    v_exp_f32 v133, v133
    v_exp_f32 v134, v134
    v_exp_f32 v135, v135
    v_exp_f32 v136, v136
    v_exp_f32 v137, v137
    v_exp_f32 v138, v138
    v_exp_f32 v139, v139
    v_pk_add_f32 v[132:133], v[132:133], 1.0 op_sel_hi:[1,0]
    v_pk_add_f32 v[134:135], v[134:135], 1.0 op_sel_hi:[1,0]
    v_pk_add_f32 v[136:137], v[136:137], 1.0 op_sel_hi:[1,0]
    v_pk_add_f32 v[138:139], v[138:139], 1.0 op_sel_hi:[1,0]
    v_rcp_f32 v132, v132
    v_rcp_f32 v133, v133
    v_rcp_f32 v134, v134
    v_rcp_f32 v135, v135
    v_rcp_f32 v136, v136
    v_rcp_f32 v137, v137
    v_rcp_f32 v138, v138
    v_rcp_f32 v139, v139
    v_pk_mul_f32 v[132:133], v[132:133], v[104:105]
    v_pk_mul_f32 v[134:135], v[134:135], v[106:107]
    v_pk_mul_f32 v[136:137], v[136:137], v[108:109]
    v_pk_mul_f32 v[138:139], v[138:139], v[110:111]
    v_cvt_pk_bf16_f32 v192, v132, v133
    v_cvt_pk_bf16_f32 v193, v134, v135
    v_cvt_pk_bf16_f32 v194, v136, v137
    v_cvt_pk_bf16_f32 v195, v138, v139
    s_waitcnt vmcnt(0)
    v_mov_b32 v16, s53
    v_mov_b32 v17, s53
    v_mov_b32 v18, s53
    v_mov_b32 v19, s53
    s_mov_b64 exec, 0xff
    buffer_store_dwordx4 v[16:19], v9, s[36:39], s66 offen sc1
    s_mov_b64 exec, -1
    v_mov_b32 v10, 163020
    v_mov_b32 v11, 1
    ds_write_b32 v10, v11
    s_add_u32 s3, s44, 0
    buffer_store_dwordx4 v[180:183], v7, s[36:39], s3 offen offset:0 sc1
    s_add_u32 s3, s44, 2048
    buffer_store_dwordx4 v[184:187], v7, s[36:39], s3 offen offset:0 sc1
    s_add_u32 s3, s44, 4096
    buffer_store_dwordx4 v[188:191], v7, s[36:39], s3 offen offset:0 sc1
    s_add_u32 s3, s44, 6144
    buffer_store_dwordx4 v[192:195], v7, s[36:39], s3 offen offset:0 sc1
    v_pk_mul_f32 v[132:133], v[28:29], v[28:29]
    v_pk_mul_f32 v[134:135], v[30:31], v[30:31]
    v_pk_mul_f32 v[136:137], v[32:33], v[32:33]
    v_pk_mul_f32 v[138:139], v[34:35], v[34:35]
    v_pk_fma_f32 v[132:133], v[132:133], v[240:241], v[242:243]
    v_pk_fma_f32 v[134:135], v[134:135], v[240:241], v[242:243]
    v_pk_fma_f32 v[136:137], v[136:137], v[240:241], v[242:243]
    v_pk_fma_f32 v[138:139], v[138:139], v[240:241], v[242:243]
    v_pk_mul_f32 v[132:133], v[132:133], v[28:29]
    v_pk_mul_f32 v[134:135], v[134:135], v[30:31]
    v_pk_mul_f32 v[136:137], v[136:137], v[32:33]
    v_pk_mul_f32 v[138:139], v[138:139], v[34:35]
    v_exp_f32 v132, v132
    v_exp_f32 v133, v133
    v_exp_f32 v134, v134
    v_exp_f32 v135, v135
    v_exp_f32 v136, v136
    v_exp_f32 v137, v137
    v_exp_f32 v138, v138
    v_exp_f32 v139, v139
    v_pk_add_f32 v[132:133], v[132:133], 1.0 op_sel_hi:[1,0]
    v_pk_add_f32 v[134:135], v[134:135], 1.0 op_sel_hi:[1,0]
    v_pk_add_f32 v[136:137], v[136:137], 1.0 op_sel_hi:[1,0]
    v_pk_add_f32 v[138:139], v[138:139], 1.0 op_sel_hi:[1,0]
    v_rcp_f32 v132, v132
    v_rcp_f32 v133, v133
    v_rcp_f32 v134, v134
    v_rcp_f32 v135, v135
    v_rcp_f32 v136, v136
    v_rcp_f32 v137, v137
    v_rcp_f32 v138, v138
    v_rcp_f32 v139, v139
    v_pk_mul_f32 v[132:133], v[132:133], v[28:29]
    v_pk_mul_f32 v[134:135], v[134:135], v[30:31]
    v_pk_mul_f32 v[136:137], v[136:137], v[32:33]
    v_pk_mul_f32 v[138:139], v[138:139], v[34:35]
    v_cvt_pk_bf16_f32 v196, v132, v133
    v_cvt_pk_bf16_f32 v197, v134, v135
    v_cvt_pk_bf16_f32 v198, v136, v137
    v_cvt_pk_bf16_f32 v199, v138, v139
    s_add_u32 s3, s44, 0
    buffer_store_dwordx4 v[196:199], v7, s[36:39], s3 offen offset:1024 sc1
    v_pk_mul_f32 v[132:133], v[56:57], v[56:57]
    v_pk_mul_f32 v[134:135], v[58:59], v[58:59]
    v_pk_mul_f32 v[136:137], v[60:61], v[60:61]
    v_pk_mul_f32 v[138:139], v[62:63], v[62:63]
    v_pk_fma_f32 v[132:133], v[132:133], v[240:241], v[242:243]
    v_pk_fma_f32 v[134:135], v[134:135], v[240:241], v[242:243]
    v_pk_fma_f32 v[136:137], v[136:137], v[240:241], v[242:243]
    v_pk_fma_f32 v[138:139], v[138:139], v[240:241], v[242:243]
    v_pk_mul_f32 v[132:133], v[132:133], v[56:57]
    v_pk_mul_f32 v[134:135], v[134:135], v[58:59]
    v_pk_mul_f32 v[136:137], v[136:137], v[60:61]
    v_pk_mul_f32 v[138:139], v[138:139], v[62:63]
    v_exp_f32 v132, v132
    v_exp_f32 v133, v133
    v_exp_f32 v134, v134
    v_exp_f32 v135, v135
    v_exp_f32 v136, v136
    v_exp_f32 v137, v137
    v_exp_f32 v138, v138
    v_exp_f32 v139, v139
    v_pk_add_f32 v[132:133], v[132:133], 1.0 op_sel_hi:[1,0]
    v_pk_add_f32 v[134:135], v[134:135], 1.0 op_sel_hi:[1,0]
    v_pk_add_f32 v[136:137], v[136:137], 1.0 op_sel_hi:[1,0]
    v_pk_add_f32 v[138:139], v[138:139], 1.0 op_sel_hi:[1,0]
    v_rcp_f32 v132, v132
    v_rcp_f32 v133, v133
    v_rcp_f32 v134, v134
    v_rcp_f32 v135, v135
    v_rcp_f32 v136, v136
    v_rcp_f32 v137, v137
    v_rcp_f32 v138, v138
    v_rcp_f32 v139, v139
    v_pk_mul_f32 v[132:133], v[132:133], v[56:57]
    v_pk_mul_f32 v[134:135], v[134:135], v[58:59]
    v_pk_mul_f32 v[136:137], v[136:137], v[60:61]
    v_pk_mul_f32 v[138:139], v[138:139], v[62:63]
    v_cvt_pk_bf16_f32 v200, v132, v133
    v_cvt_pk_bf16_f32 v201, v134, v135
    v_cvt_pk_bf16_f32 v202, v136, v137
    v_cvt_pk_bf16_f32 v203, v138, v139
    s_add_u32 s3, s44, 2048
    buffer_store_dwordx4 v[200:203], v7, s[36:39], s3 offen offset:1024 sc1
    v_pk_mul_f32 v[132:133], v[84:85], v[84:85]
    v_pk_mul_f32 v[134:135], v[86:87], v[86:87]
    v_pk_mul_f32 v[136:137], v[88:89], v[88:89]
    v_pk_mul_f32 v[138:139], v[90:91], v[90:91]
    v_pk_fma_f32 v[132:133], v[132:133], v[240:241], v[242:243]
    v_pk_fma_f32 v[134:135], v[134:135], v[240:241], v[242:243]
    v_pk_fma_f32 v[136:137], v[136:137], v[240:241], v[242:243]
    v_pk_fma_f32 v[138:139], v[138:139], v[240:241], v[242:243]
    v_pk_mul_f32 v[132:133], v[132:133], v[84:85]
    v_pk_mul_f32 v[134:135], v[134:135], v[86:87]
    v_pk_mul_f32 v[136:137], v[136:137], v[88:89]
    v_pk_mul_f32 v[138:139], v[138:139], v[90:91]
    v_exp_f32 v132, v132
    v_exp_f32 v133, v133
    v_exp_f32 v134, v134
    v_exp_f32 v135, v135
    v_exp_f32 v136, v136
    v_exp_f32 v137, v137
    v_exp_f32 v138, v138
    v_exp_f32 v139, v139
    v_pk_add_f32 v[132:133], v[132:133], 1.0 op_sel_hi:[1,0]
    v_pk_add_f32 v[134:135], v[134:135], 1.0 op_sel_hi:[1,0]
    v_pk_add_f32 v[136:137], v[136:137], 1.0 op_sel_hi:[1,0]
    v_pk_add_f32 v[138:139], v[138:139], 1.0 op_sel_hi:[1,0]
    v_rcp_f32 v132, v132
    v_rcp_f32 v133, v133
    v_rcp_f32 v134, v134
    v_rcp_f32 v135, v135
    v_rcp_f32 v136, v136
    v_rcp_f32 v137, v137
    v_rcp_f32 v138, v138
    v_rcp_f32 v139, v139
    v_pk_mul_f32 v[132:133], v[132:133], v[84:85]
    v_pk_mul_f32 v[134:135], v[134:135], v[86:87]
    v_pk_mul_f32 v[136:137], v[136:137], v[88:89]
    v_pk_mul_f32 v[138:139], v[138:139], v[90:91]
    v_cvt_pk_bf16_f32 v204, v132, v133
    v_cvt_pk_bf16_f32 v205, v134, v135
    v_cvt_pk_bf16_f32 v206, v136, v137
    v_cvt_pk_bf16_f32 v207, v138, v139
    s_add_u32 s3, s44, 4096
    buffer_store_dwordx4 v[204:207], v7, s[36:39], s3 offen offset:1024 sc1
    v_pk_mul_f32 v[132:133], v[112:113], v[112:113]
    v_pk_mul_f32 v[134:135], v[114:115], v[114:115]
    v_pk_mul_f32 v[136:137], v[116:117], v[116:117]
    v_pk_mul_f32 v[138:139], v[118:119], v[118:119]
    v_pk_fma_f32 v[132:133], v[132:133], v[240:241], v[242:243]
    v_pk_fma_f32 v[134:135], v[134:135], v[240:241], v[242:243]
    v_pk_fma_f32 v[136:137], v[136:137], v[240:241], v[242:243]
    v_pk_fma_f32 v[138:139], v[138:139], v[240:241], v[242:243]
    v_pk_mul_f32 v[132:133], v[132:133], v[112:113]
    v_pk_mul_f32 v[134:135], v[134:135], v[114:115]
    v_pk_mul_f32 v[136:137], v[136:137], v[116:117]
    v_pk_mul_f32 v[138:139], v[138:139], v[118:119]
    v_exp_f32 v132, v132
    v_exp_f32 v133, v133
    v_exp_f32 v134, v134
    v_exp_f32 v135, v135
    v_exp_f32 v136, v136
    v_exp_f32 v137, v137
    v_exp_f32 v138, v138
    v_exp_f32 v139, v139
    v_pk_add_f32 v[132:133], v[132:133], 1.0 op_sel_hi:[1,0]
    v_pk_add_f32 v[134:135], v[134:135], 1.0 op_sel_hi:[1,0]
    v_pk_add_f32 v[136:137], v[136:137], 1.0 op_sel_hi:[1,0]
    v_pk_add_f32 v[138:139], v[138:139], 1.0 op_sel_hi:[1,0]
    v_rcp_f32 v132, v132
    v_rcp_f32 v133, v133
    v_rcp_f32 v134, v134
    v_rcp_f32 v135, v135
    v_rcp_f32 v136, v136
    v_rcp_f32 v137, v137
    v_rcp_f32 v138, v138
    v_rcp_f32 v139, v139
    v_pk_mul_f32 v[132:133], v[132:133], v[112:113]
    v_pk_mul_f32 v[134:135], v[134:135], v[114:115]
    v_pk_mul_f32 v[136:137], v[136:137], v[116:117]
    v_pk_mul_f32 v[138:139], v[138:139], v[118:119]
    v_cvt_pk_bf16_f32 v208, v132, v133
    v_cvt_pk_bf16_f32 v209, v134, v135
    v_cvt_pk_bf16_f32 v210, v136, v137
    v_cvt_pk_bf16_f32 v211, v138, v139
    s_add_u32 s3, s44, 6144
    buffer_store_dwordx4 v[208:211], v7, s[36:39], s3 offen offset:1024 sc1
    v_pk_mul_f32 v[132:133], v[44:45], v[44:45]
    v_pk_mul_f32 v[134:135], v[46:47], v[46:47]
    v_pk_mul_f32 v[136:137], v[72:73], v[72:73]
    v_pk_mul_f32 v[138:139], v[74:75], v[74:75]
    v_pk_fma_f32 v[132:133], v[132:133], v[240:241], v[242:243]
    v_pk_fma_f32 v[134:135], v[134:135], v[240:241], v[242:243]
    v_pk_fma_f32 v[136:137], v[136:137], v[240:241], v[242:243]
    v_pk_fma_f32 v[138:139], v[138:139], v[240:241], v[242:243]
    v_pk_mul_f32 v[132:133], v[132:133], v[44:45]
    v_pk_mul_f32 v[134:135], v[134:135], v[46:47]
    v_pk_mul_f32 v[136:137], v[136:137], v[72:73]
    v_pk_mul_f32 v[138:139], v[138:139], v[74:75]
    v_exp_f32 v132, v132
    v_exp_f32 v133, v133
    v_exp_f32 v134, v134
    v_exp_f32 v135, v135
    v_exp_f32 v136, v136
    v_exp_f32 v137, v137
    v_exp_f32 v138, v138
    v_exp_f32 v139, v139
    v_pk_add_f32 v[132:133], v[132:133], 1.0 op_sel_hi:[1,0]
    v_pk_add_f32 v[134:135], v[134:135], 1.0 op_sel_hi:[1,0]
    v_pk_add_f32 v[136:137], v[136:137], 1.0 op_sel_hi:[1,0]
    v_pk_add_f32 v[138:139], v[138:139], 1.0 op_sel_hi:[1,0]
    v_rcp_f32 v132, v132
    v_rcp_f32 v133, v133
    v_rcp_f32 v134, v134
    v_rcp_f32 v135, v135
    v_rcp_f32 v136, v136
    v_rcp_f32 v137, v137
    v_rcp_f32 v138, v138
    v_rcp_f32 v139, v139
    v_pk_mul_f32 v[132:133], v[132:133], v[44:45]
    v_pk_mul_f32 v[134:135], v[134:135], v[46:47]
    v_pk_mul_f32 v[136:137], v[136:137], v[72:73]
    v_pk_mul_f32 v[138:139], v[138:139], v[74:75]
    v_cvt_pk_bf16_f32 v212, v132, v133
    v_cvt_pk_bf16_f32 v213, v134, v135
    v_cvt_pk_bf16_f32 v214, v136, v137
    v_cvt_pk_bf16_f32 v215, v138, v139
    s_nop 0
    v_permlane32_swap_b32 v212, v214
    v_permlane32_swap_b32 v213, v215
    v_pk_mul_f32 v[132:133], v[100:101], v[100:101]
    v_pk_mul_f32 v[134:135], v[102:103], v[102:103]
    v_pk_mul_f32 v[136:137], v[128:129], v[128:129]
    v_pk_mul_f32 v[138:139], v[130:131], v[130:131]
    v_pk_fma_f32 v[132:133], v[132:133], v[240:241], v[242:243]
    v_pk_fma_f32 v[134:135], v[134:135], v[240:241], v[242:243]
    v_pk_fma_f32 v[136:137], v[136:137], v[240:241], v[242:243]
    v_pk_fma_f32 v[138:139], v[138:139], v[240:241], v[242:243]
    v_pk_mul_f32 v[132:133], v[132:133], v[100:101]
    v_pk_mul_f32 v[134:135], v[134:135], v[102:103]
    v_pk_mul_f32 v[136:137], v[136:137], v[128:129]
    v_pk_mul_f32 v[138:139], v[138:139], v[130:131]
    v_exp_f32 v132, v132
    v_exp_f32 v133, v133
    v_exp_f32 v134, v134
    v_exp_f32 v135, v135
    v_exp_f32 v136, v136
    v_exp_f32 v137, v137
    v_exp_f32 v138, v138
    v_exp_f32 v139, v139
    v_pk_add_f32 v[132:133], v[132:133], 1.0 op_sel_hi:[1,0]
    v_pk_add_f32 v[134:135], v[134:135], 1.0 op_sel_hi:[1,0]
    v_pk_add_f32 v[136:137], v[136:137], 1.0 op_sel_hi:[1,0]
    v_pk_add_f32 v[138:139], v[138:139], 1.0 op_sel_hi:[1,0]
    v_rcp_f32 v132, v132
    v_rcp_f32 v133, v133
    v_rcp_f32 v134, v134
    v_rcp_f32 v135, v135
    v_rcp_f32 v136, v136
    v_rcp_f32 v137, v137
    v_rcp_f32 v138, v138
    v_rcp_f32 v139, v139
    v_pk_mul_f32 v[132:133], v[132:133], v[100:101]
    v_pk_mul_f32 v[134:135], v[134:135], v[102:103]
    v_pk_mul_f32 v[136:137], v[136:137], v[128:129]
    v_pk_mul_f32 v[138:139], v[138:139], v[130:131]
    v_cvt_pk_bf16_f32 v216, v132, v133
    v_cvt_pk_bf16_f32 v217, v134, v135
    v_cvt_pk_bf16_f32 v218, v136, v137
    v_cvt_pk_bf16_f32 v219, v138, v139
    s_nop 0
    v_permlane32_swap_b32 v216, v218
    v_permlane32_swap_b32 v217, v219
    v_mov_b32 v220, v7
    v_mov_b32 v221, v8
    s_mov_b32 s69, s44
    s_mov_b32 s71, s50
    s_and_b32 s57, s2, 7
    s_lshr_b32 s58, s2, 3
    s_lshr_b32 s60, s57, 1
    s_lshl_b32 s60, s60, 2
    s_and_b32 s3, s58, 3
    s_add_u32 s60, s60, s3
    s_and_b32 s61, s57, 1
    s_lshr_b32 s62, s58, 2
    s_lshl_b32 s62, s62, 8
    s_lshl_b32 s3, s61, 7
    s_add_u32 s62, s62, s3
    s_xor_b32 s63, s62, 128
    v_lshrrev_b32 v3, 4, v2
    v_and_b32 v4, 15, v2
    v_lshrrev_b32 v6, 2, v2
    v_and_b32 v6, 7, v6
    v_lshrrev_b32 v7, 1, v6
    v_lshlrev_b32 v7, 5, v7
    v_lshl_add_u32 v7, v6, 7, v7
    v_and_b32 v8, 3, v2
    v_lshl_add_u32 v7, v8, 3, v7
    v_lshrrev_b32 v9, 5, v2
    v_lshl_add_u32 v7, v9, 10, v7
    s_lshl_b32 s3, s64, 13
    s_add_u32 s3, s3, 94208
    v_lshlrev_b32 v9, 4, v2
    v_add_u32 v5, s3, v9
    s_lshl_b32 s3, s65, 6
    v_xor_b32 v10, s3, v7
    v_xor_b32 v10, 0, v10
    v_add_u32 v10, 28672, v10
    v_xor_b32 v11, s3, v7
    v_xor_b32 v11, 32, v11
    v_add_u32 v11, 28672, v11
    s_add_u32 s44, s62, s3
    s_xor_b32 s3, s2, 1
    s_lshl_b32 s3, s3, 2
    s_add_u32 s3, s3, s52
    s_lshl_b32 s46, s3, 12
    s_add_u32 s46, s46, 33554432
    s_lshl_b32 s47, s3, 7
    s_add_u32 s47, s47, 393216
    s_lshl_b32 s3, s2, 2
    s_add_u32 s3, s3, s52
    s_lshl_b32 s48, s3, 12
    s_add_u32 s48, s48, 33554432
    s_lshl_b32 s49, s3, 7
    s_add_u32 s49, s49, 393216
    s_lshr_b32 s45, s44, 7
    s_lshl_b32 s45, s45, 18
    s_lshl_b32 s3, s65, 10
    s_add_u32 s45, s45, s3
    s_lshl_b32 s3, s60, 14
    s_add_u32 s45, s45, s3
    s_lshl_b32 s3, s64, 13
    s_add_u32 s45, s45, s3
    s_add_u32 s45, s45, 9437184
    s_add_u32 s50, s45, 4096
    v_mov_b32 v19, 0
    v_lshlrev_b32 v20, 16, v224
    v_and_b32 v21, 0xffff0000, v224
    v_lshlrev_b32 v22, 16, v225
    v_and_b32 v23, 0xffff0000, v225
    v_lshlrev_b32 v24, 16, v226
    v_and_b32 v25, 0xffff0000, v226
    v_lshlrev_b32 v26, 16, v227
    v_and_b32 v27, 0xffff0000, v227
    v_mov_b32 v28, 0
    v_mov_b32 v29, 0
    v_mov_b32 v30, 0
    v_mov_b32 v31, 0
    v_mov_b32 v32, 0
    v_mov_b32 v33, 0
    v_mov_b32 v34, 0
    v_mov_b32 v35, 0
    v_mov_b32 v36, v20
    v_mov_b32 v37, v21
    v_mov_b32 v38, v22
    v_mov_b32 v39, v23
    v_mov_b32 v40, v24
    v_mov_b32 v41, v25
    v_mov_b32 v42, v26
    v_mov_b32 v43, v27
    v_mov_b32 v44, 0
    v_mov_b32 v45, 0
    v_mov_b32 v46, 0
    v_mov_b32 v47, 0
    v_mov_b32 v48, 0
    v_mov_b32 v49, 0
    v_mov_b32 v50, 0
    v_mov_b32 v51, 0
    v_mov_b32 v52, v20
    v_mov_b32 v53, v21
    v_mov_b32 v54, v22
    v_mov_b32 v55, v23
    v_mov_b32 v56, v24
    v_mov_b32 v57, v25
    v_mov_b32 v58, v26
    v_mov_b32 v59, v27
    v_mov_b32 v60, 0
    v_mov_b32 v61, 0
    v_mov_b32 v62, 0
    v_mov_b32 v63, 0
    v_mov_b32 v64, 0
    v_mov_b32 v65, 0
    v_mov_b32 v66, 0
    v_mov_b32 v67, 0
    v_mov_b32 v68, v20
    v_mov_b32 v69, v21
    v_mov_b32 v70, v22
    v_mov_b32 v71, v23
    v_mov_b32 v72, v24
    v_mov_b32 v73, v25
    v_mov_b32 v74, v26
    v_mov_b32 v75, v27
    v_mov_b32 v76, 0
    v_mov_b32 v77, 0
    v_mov_b32 v78, 0
    v_mov_b32 v79, 0
    v_mov_b32 v80, 0
    v_mov_b32 v81, 0
    v_mov_b32 v82, 0
    v_mov_b32 v83, 0
    v_cvt_pk_bf16_f32 v228, v228, v228
    v_lshlrev_b32 v228, 16, v228
    v_cvt_pk_bf16_f32 v229, v229, v229
    v_lshlrev_b32 v229, 16, v229
    v_cvt_pk_bf16_f32 v230, v230, v230
    v_lshlrev_b32 v230, 16, v230
    v_cvt_pk_bf16_f32 v231, v231, v231
    v_lshlrev_b32 v231, 16, v231
    v_cvt_pk_bf16_f32 v232, v232, v232
    v_lshlrev_b32 v232, 16, v232
    v_cvt_pk_bf16_f32 v233, v233, v233
    v_lshlrev_b32 v233, 16, v233
    v_cvt_pk_bf16_f32 v234, v234, v234
    v_lshlrev_b32 v234, 16, v234
    v_cvt_pk_bf16_f32 v235, v235, v235
    v_lshlrev_b32 v235, 16, v235
    s_mov_b32 s59, 23
    s_mov_b32 s58, 1
    s_mov_b32 s66, 16384
    s_mov_b32 s68, s66
    s_mov_b32 s70, 4294918144
    s_mov_b32 s21, 23
    s_lshl_b32 s3, s60, 18
    s_lshl_b32 s57, s64, 17
    s_add_u32 s3, s3, s57
    s_add_u32 s3, s3, s44
    v_lshlrev_b32 v17, 11, v4
    v_and_b32 v16, 1, v3
    v_lshl_add_u32 v17, v16, 5, v17
    v_lshrrev_b32 v16, 1, v3
    v_lshl_add_u32 v17, v16, 4, v17
    v_add_u32 v17, s3, v17
    s_barrier
    ds_read_b128 v[84:87], v5 offset:0
    ds_read_b128 v[88:91], v5 offset:2048
    ds_read_b128 v[92:95], v5 offset:4096
    ds_read_b128 v[96:99], v5 offset:6144
    ds_read_b64_tr_b16 v[116:117], v10 offset:0
    ds_read_b64_tr_b16 v[118:119], v10 offset:2048
    ds_read_b64_tr_b16 v[120:121], v11 offset:0
    ds_read_b64_tr_b16 v[122:123], v11 offset:2048
    ds_read_b64_tr_b16 v[124:125], v10 offset:8192
    ds_read_b64_tr_b16 v[126:127], v10 offset:10240
    ds_read_b64_tr_b16 v[128:129], v11 offset:8192
    ds_read_b64_tr_b16 v[130:131], v11 offset:10240
    s_waitcnt lgkmcnt(0)
.p2align 3
c2a_10:
    v_mfma_f32_16x16x32_bf16 v[20:23], v[116:119], v[84:87], v[20:23]
    ds_read_b128 v[100:103], v5 offset:1024
    ds_read_b128 v[104:107], v5 offset:3072
    v_mfma_f32_16x16x32_bf16 v[24:27], v[120:123], v[84:87], v[24:27]
    ds_read_b128 v[108:111], v5 offset:5120
    ds_read_b128 v[112:115], v5 offset:7168
    v_mfma_f32_16x16x32_bf16 v[28:31], v[124:127], v[84:87], v[28:31]
    ds_read_b64_tr_b16 v[132:133], v10 offset:4096
    ds_read_b64_tr_b16 v[134:135], v10 offset:6144
    v_mfma_f32_16x16x32_bf16 v[32:35], v[128:131], v[84:87], v[32:35]
    ds_read_b64_tr_b16 v[136:137], v11 offset:4096
    ds_read_b64_tr_b16 v[138:139], v11 offset:6144
    v_mfma_f32_16x16x32_bf16 v[36:39], v[116:119], v[88:91], v[36:39]
    ds_read_b64_tr_b16 v[140:141], v10 offset:12288
    v_mfma_f32_16x16x32_bf16 v[40:43], v[120:123], v[88:91], v[40:43]
    ds_read_b64_tr_b16 v[142:143], v10 offset:14336
    v_mfma_f32_16x16x32_bf16 v[44:47], v[124:127], v[88:91], v[44:47]
    ds_read_b64_tr_b16 v[144:145], v11 offset:12288
    v_mfma_f32_16x16x32_bf16 v[48:51], v[128:131], v[88:91], v[48:51]
    ds_read_b64_tr_b16 v[146:147], v11 offset:14336
    v_mfma_f32_16x16x32_bf16 v[52:55], v[116:119], v[92:95], v[52:55]
    v_add_u32 v5, s68, v5
    v_add_u32 v10, s68, v10
    v_mfma_f32_16x16x32_bf16 v[56:59], v[120:123], v[92:95], v[56:59]
    v_add_u32 v11, s68, v11
    s_nop 0
    v_mfma_f32_16x16x32_bf16 v[60:63], v[124:127], v[92:95], v[60:63]
    v_mfma_f32_16x16x32_bf16 v[64:67], v[128:131], v[92:95], v[64:67]
    s_cmp_eq_u32 s59, s21
    s_cbranch_scc1 L_s4b
L_s4br:
    v_mfma_f32_16x16x32_bf16 v[68:71], v[116:119], v[96:99], v[68:71]
    v_mfma_f32_16x16x32_bf16 v[72:75], v[120:123], v[96:99], v[72:75]
    v_mfma_f32_16x16x32_bf16 v[76:79], v[124:127], v[96:99], v[76:79]
    s_waitcnt lgkmcnt(0)
    s_barrier
    v_mfma_f32_16x16x32_bf16 v[80:83], v[128:131], v[96:99], v[80:83]
    v_mfma_f32_16x16x32_bf16 v[20:23], v[132:135], v[100:103], v[20:23]
    ds_read_b128 v[84:87], v5 offset:0
    ds_read_b128 v[88:91], v5 offset:2048
    v_mfma_f32_16x16x32_bf16 v[24:27], v[136:139], v[100:103], v[24:27]
    ds_read_b128 v[92:95], v5 offset:4096
    ds_read_b128 v[96:99], v5 offset:6144
    v_mfma_f32_16x16x32_bf16 v[28:31], v[140:143], v[100:103], v[28:31]
    ds_read_b64_tr_b16 v[116:117], v10 offset:0
    ds_read_b64_tr_b16 v[118:119], v10 offset:2048
    v_mfma_f32_16x16x32_bf16 v[32:35], v[144:147], v[100:103], v[32:35]
    ds_read_b64_tr_b16 v[120:121], v11 offset:0
    ds_read_b64_tr_b16 v[122:123], v11 offset:2048
    v_mfma_f32_16x16x32_bf16 v[36:39], v[132:135], v[104:107], v[36:39]
    ds_read_b64_tr_b16 v[124:125], v10 offset:8192
    v_mfma_f32_16x16x32_bf16 v[40:43], v[136:139], v[104:107], v[40:43]
    ds_read_b64_tr_b16 v[126:127], v10 offset:10240
    v_mfma_f32_16x16x32_bf16 v[44:47], v[140:143], v[104:107], v[44:47]
    ds_read_b64_tr_b16 v[128:129], v11 offset:8192
    v_mfma_f32_16x16x32_bf16 v[48:51], v[144:147], v[104:107], v[48:51]
    ds_read_b64_tr_b16 v[130:131], v11 offset:10240
    v_mfma_f32_16x16x32_bf16 v[52:55], v[132:135], v[108:111], v[52:55]
    s_add_u32 s58, s58, 1
    s_and_b32 s58, s58, 3
    v_mfma_f32_16x16x32_bf16 v[56:59], v[136:139], v[108:111], v[56:59]
    s_cselect_b32 s68, s66, s70
    s_sub_u32 s59, s59, 1
    v_mfma_f32_16x16x32_bf16 v[60:63], v[140:143], v[108:111], v[60:63]
    v_mfma_f32_16x16x32_bf16 v[64:67], v[144:147], v[108:111], v[64:67]
    v_mfma_f32_16x16x32_bf16 v[68:71], v[132:135], v[112:115], v[68:71]
    v_mfma_f32_16x16x32_bf16 v[72:75], v[136:139], v[112:115], v[72:75]
    v_mfma_f32_16x16x32_bf16 v[76:79], v[140:143], v[112:115], v[76:79]
    s_waitcnt lgkmcnt(0)
    s_nop 0
    v_mfma_f32_16x16x32_bf16 v[80:83], v[144:147], v[112:115], v[80:83]
    s_cbranch_scc0 c2a_10
    v_cvt_pk_bf16_f32 v164, v28, v29
    v_cvt_pk_bf16_f32 v165, v30, v31
    v_cvt_pk_bf16_f32 v166, v32, v33
    v_cvt_pk_bf16_f32 v167, v34, v35
    buffer_store_dwordx4 v[164:167], v9, s[36:39], s46 offen offset:0 sc1
    v_cvt_pk_bf16_f32 v168, v44, v45
    v_cvt_pk_bf16_f32 v169, v46, v47
    v_cvt_pk_bf16_f32 v170, v48, v49
    v_cvt_pk_bf16_f32 v171, v50, v51
    buffer_store_dwordx4 v[168:171], v9, s[36:39], s46 offen offset:1024 sc1
    v_cvt_pk_bf16_f32 v172, v60, v61
    v_cvt_pk_bf16_f32 v173, v62, v63
    v_cvt_pk_bf16_f32 v174, v64, v65
    v_cvt_pk_bf16_f32 v175, v66, v67
    buffer_store_dwordx4 v[172:175], v9, s[36:39], s46 offen offset:2048 sc1
    v_cvt_pk_bf16_f32 v176, v76, v77
    v_cvt_pk_bf16_f32 v177, v78, v79
    v_cvt_pk_bf16_f32 v178, v80, v81
    v_cvt_pk_bf16_f32 v179, v82, v83
    buffer_store_dwordx4 v[176:179], v9, s[36:39], s46 offen offset:3072 sc1
    buffer_load_dwordx4 v[148:151], v9, s[36:39], s45 offen offset:0 sc1
    buffer_load_dwordx4 v[152:155], v9, s[36:39], s45 offen offset:2048 sc1
    buffer_load_dwordx4 v[156:159], v9, s[36:39], s50 offen offset:0 sc1
    buffer_load_dwordx4 v[160:163], v9, s[36:39], s50 offen offset:2048 sc1
    s_mov_b32 s59, 7
c2b_11:
    s_cmp_lg_u32 s59, 5
    s_cbranch_scc1 c2x_12
    s_waitcnt vmcnt(4)
    v_mov_b32 v12, s53
    v_mov_b32 v13, s53
    v_mov_b32 v14, s53
    v_mov_b32 v15, s53
    s_mov_b64 exec, 0xff
    buffer_store_dwordx4 v[12:15], v9, s[36:39], s47 offen sc1
    s_mov_b64 exec, -1
c2x_12:
    s_cmp_lg_u32 s59, 2
    s_cbranch_scc1 c2y_13
    buffer_load_dword v222, v19, s[36:39], s49 offen sc1
c2y_13:
    s_cmp_lg_u32 s59, 0
    s_cbranch_scc1 c2z_14
    s_waitcnt vmcnt(0)
    v_cmp_ne_u32 vcc, s53, v222
    s_nop 1
    s_cbranch_vccz s5ok_15
    s_mov_b32 s57, 0
poll_16:
    buffer_load_dword v222, v19, s[36:39], s49 offen sc1
    s_waitcnt vmcnt(0)
    v_cmp_ne_u32 vcc, s53, v222
    s_nop 1
    s_cbranch_vccz pdone_17
    s_add_u32 s57, s57, 1
    s_cmp_lt_u32 s57, 0x40000
    s_cbranch_scc1 poll_16
pdone_17:
s5ok_15:
    buffer_load_dwordx4 v[164:167], v9, s[36:39], s48 offen offset:0 sc1
    buffer_load_dwordx4 v[168:171], v9, s[36:39], s48 offen offset:1024 sc1
    buffer_load_dwordx4 v[172:175], v9, s[36:39], s48 offen offset:2048 sc1
    buffer_load_dwordx4 v[176:179], v9, s[36:39], s48 offen offset:3072 sc1
c2z_14:
    v_mfma_f32_16x16x32_bf16 v[20:23], v[116:119], v[84:87], v[20:23]
    ds_read_b128 v[100:103], v5 offset:1024
    ds_read_b128 v[104:107], v5 offset:3072
    ds_read_b128 v[108:111], v5 offset:5120
    v_mfma_f32_16x16x32_bf16 v[24:27], v[120:123], v[84:87], v[24:27]
    ds_read_b128 v[112:115], v5 offset:7168
    ds_read_b64_tr_b16 v[132:133], v10 offset:4096
    ds_read_b64_tr_b16 v[134:135], v10 offset:6144
    v_mfma_f32_16x16x32_bf16 v[36:39], v[116:119], v[88:91], v[36:39]
    ds_read_b64_tr_b16 v[136:137], v11 offset:4096
    ds_read_b64_tr_b16 v[138:139], v11 offset:6144
    v_mfma_f32_16x16x32_bf16 v[40:43], v[120:123], v[88:91], v[40:43]
    v_add_u32 v5, s68, v5
    v_add_u32 v10, s68, v10
    v_mfma_f32_16x16x32_bf16 v[52:55], v[116:119], v[92:95], v[52:55]
    v_add_u32 v11, s68, v11
    s_nop 0
    v_mfma_f32_16x16x32_bf16 v[56:59], v[120:123], v[92:95], v[56:59]
    v_mfma_f32_16x16x32_bf16 v[68:71], v[116:119], v[96:99], v[68:71]
    v_mfma_f32_16x16x32_bf16 v[72:75], v[120:123], v[96:99], v[72:75]
    s_waitcnt lgkmcnt(0)
    s_barrier
    v_mfma_f32_16x16x32_bf16 v[20:23], v[132:135], v[100:103], v[20:23]
    ds_read_b128 v[84:87], v5 offset:0
    ds_read_b128 v[88:91], v5 offset:2048
    ds_read_b128 v[92:95], v5 offset:4096
    v_mfma_f32_16x16x32_bf16 v[24:27], v[136:139], v[100:103], v[24:27]
    ds_read_b128 v[96:99], v5 offset:6144
    ds_read_b64_tr_b16 v[116:117], v10 offset:0
    ds_read_b64_tr_b16 v[118:119], v10 offset:2048
    v_mfma_f32_16x16x32_bf16 v[36:39], v[132:135], v[104:107], v[36:39]
    ds_read_b64_tr_b16 v[120:121], v11 offset:0
    ds_read_b64_tr_b16 v[122:123], v11 offset:2048
    v_mfma_f32_16x16x32_bf16 v[40:43], v[136:139], v[104:107], v[40:43]
    s_add_u32 s58, s58, 1
    s_and_b32 s58, s58, 3
    v_mfma_f32_16x16x32_bf16 v[52:55], v[132:135], v[108:111], v[52:55]
    s_cselect_b32 s68, s66, s70
    s_sub_u32 s59, s59, 1
    v_mfma_f32_16x16x32_bf16 v[56:59], v[136:139], v[108:111], v[56:59]
    v_mfma_f32_16x16x32_bf16 v[68:71], v[132:135], v[112:115], v[68:71]
    v_mfma_f32_16x16x32_bf16 v[72:75], v[136:139], v[112:115], v[72:75]
    s_waitcnt lgkmcnt(0)
    s_cbranch_scc0 c2b_11
    s_mov_b32 s40, s30
    s_mov_b32 s41, s31
    s_mov_b32 s42, 4194304
    s_mov_b32 s43, 0x20000
    v_lshlrev_b32 v84, 16, v148
    v_and_b32 v85, 0xffff0000, v148
    v_lshlrev_b32 v86, 16, v149
    v_and_b32 v87, 0xffff0000, v149
    v_lshlrev_b32 v88, 16, v150
    v_and_b32 v89, 0xffff0000, v150
    v_lshlrev_b32 v90, 16, v151
    v_and_b32 v91, 0xffff0000, v151
    v_fmac_f32 v84, v20, v228
    v_fmac_f32 v85, v21, v229
    v_fmac_f32 v86, v22, v230
    v_fmac_f32 v87, v23, v231
    v_fmac_f32 v88, v24, v232
    v_fmac_f32 v89, v25, v233
    v_fmac_f32 v90, v26, v234
    v_fmac_f32 v91, v27, v235
    v_lshlrev_b32 v92, 16, v152
    v_and_b32 v93, 0xffff0000, v152
    v_lshlrev_b32 v94, 16, v153
    v_and_b32 v95, 0xffff0000, v153
    v_lshlrev_b32 v96, 16, v154
    v_and_b32 v97, 0xffff0000, v154
    v_lshlrev_b32 v98, 16, v155
    v_and_b32 v99, 0xffff0000, v155
    v_fmac_f32 v92, v36, v228
    v_fmac_f32 v93, v37, v229
    v_fmac_f32 v94, v38, v230
    v_fmac_f32 v95, v39, v231
    v_fmac_f32 v96, v40, v232
    v_fmac_f32 v97, v41, v233
    v_fmac_f32 v98, v42, v234
    v_fmac_f32 v99, v43, v235
    v_lshlrev_b32 v100, 16, v156
    v_and_b32 v101, 0xffff0000, v156
    v_lshlrev_b32 v102, 16, v157
    v_and_b32 v103, 0xffff0000, v157
    v_lshlrev_b32 v104, 16, v158
    v_and_b32 v105, 0xffff0000, v158
    v_lshlrev_b32 v106, 16, v159
    v_and_b32 v107, 0xffff0000, v159
    v_fmac_f32 v100, v52, v228
    v_fmac_f32 v101, v53, v229
    v_fmac_f32 v102, v54, v230
    v_fmac_f32 v103, v55, v231
    v_fmac_f32 v104, v56, v232
    v_fmac_f32 v105, v57, v233
    v_fmac_f32 v106, v58, v234
    v_fmac_f32 v107, v59, v235
    v_lshlrev_b32 v108, 16, v160
    v_and_b32 v109, 0xffff0000, v160
    v_lshlrev_b32 v110, 16, v161
    v_and_b32 v111, 0xffff0000, v161
    v_lshlrev_b32 v112, 16, v162
    v_and_b32 v113, 0xffff0000, v162
    v_lshlrev_b32 v114, 16, v163
    v_and_b32 v115, 0xffff0000, v163
    v_fmac_f32 v108, v68, v228
    v_fmac_f32 v109, v69, v229
    v_fmac_f32 v110, v70, v230
    v_fmac_f32 v111, v71, v231
    v_fmac_f32 v112, v72, v232
    v_fmac_f32 v113, v73, v233
    v_fmac_f32 v114, v74, v234
    v_fmac_f32 v115, v75, v235
    s_waitcnt vmcnt(3)
    v_lshlrev_b32 v116, 16, v164
    v_and_b32 v117, 0xffff0000, v164
    v_lshlrev_b32 v118, 16, v165
    v_and_b32 v119, 0xffff0000, v165
    v_lshlrev_b32 v120, 16, v166
    v_and_b32 v121, 0xffff0000, v166
    v_lshlrev_b32 v122, 16, v167
    v_and_b32 v123, 0xffff0000, v167
    v_fmac_f32 v84, v116, v228
    v_fmac_f32 v85, v117, v229
    v_fmac_f32 v86, v118, v230
    v_fmac_f32 v87, v119, v231
    v_fmac_f32 v88, v120, v232
    v_fmac_f32 v89, v121, v233
    v_fmac_f32 v90, v122, v234
    v_fmac_f32 v91, v123, v235
    v_cvt_pk_bf16_f32 v148, v84, v85
    v_cvt_pk_bf16_f32 v149, v86, v87
    v_cvt_pk_bf16_f32 v150, v88, v89
    v_cvt_pk_bf16_f32 v151, v90, v91
    s_nop 0
    v_permlane16_swap_b32 v148, v150
    v_permlane16_swap_b32 v149, v151
    s_mov_b32 s3, 0
    buffer_store_dwordx4 v[148:151], v17, s[40:43], s3 offen
    s_waitcnt vmcnt(3)
    v_lshlrev_b32 v116, 16, v168
    v_and_b32 v117, 0xffff0000, v168
    v_lshlrev_b32 v118, 16, v169
    v_and_b32 v119, 0xffff0000, v169
    v_lshlrev_b32 v120, 16, v170
    v_and_b32 v121, 0xffff0000, v170
    v_lshlrev_b32 v122, 16, v171
    v_and_b32 v123, 0xffff0000, v171
    v_fmac_f32 v92, v116, v228
    v_fmac_f32 v93, v117, v229
    v_fmac_f32 v94, v118, v230
    v_fmac_f32 v95, v119, v231
    v_fmac_f32 v96, v120, v232
    v_fmac_f32 v97, v121, v233
    v_fmac_f32 v98, v122, v234
    v_fmac_f32 v99, v123, v235
    v_cvt_pk_bf16_f32 v152, v92, v93
    v_cvt_pk_bf16_f32 v153, v94, v95
    v_cvt_pk_bf16_f32 v154, v96, v97
    v_cvt_pk_bf16_f32 v155, v98, v99
    s_nop 0
    v_permlane16_swap_b32 v152, v154
    v_permlane16_swap_b32 v153, v155
    s_mov_b32 s3, 32768
    buffer_store_dwordx4 v[152:155], v17, s[40:43], s3 offen
    s_waitcnt vmcnt(3)
    v_lshlrev_b32 v116, 16, v172
    v_and_b32 v117, 0xffff0000, v172
    v_lshlrev_b32 v118, 16, v173
    v_and_b32 v119, 0xffff0000, v173
    v_lshlrev_b32 v120, 16, v174
    v_and_b32 v121, 0xffff0000, v174
    v_lshlrev_b32 v122, 16, v175
    v_and_b32 v123, 0xffff0000, v175
    v_fmac_f32 v100, v116, v228
    v_fmac_f32 v101, v117, v229
    v_fmac_f32 v102, v118, v230
    v_fmac_f32 v103, v119, v231
    v_fmac_f32 v104, v120, v232
    v_fmac_f32 v105, v121, v233
    v_fmac_f32 v106, v122, v234
    v_fmac_f32 v107, v123, v235
    v_cvt_pk_bf16_f32 v156, v100, v101
    v_cvt_pk_bf16_f32 v157, v102, v103
    v_cvt_pk_bf16_f32 v158, v104, v105
    v_cvt_pk_bf16_f32 v159, v106, v107
    s_nop 0
    v_permlane16_swap_b32 v156, v158
    v_permlane16_swap_b32 v157, v159
    s_mov_b32 s3, 65536
    buffer_store_dwordx4 v[156:159], v17, s[40:43], s3 offen
    s_waitcnt vmcnt(3)
    v_lshlrev_b32 v116, 16, v176
    v_and_b32 v117, 0xffff0000, v176
    v_lshlrev_b32 v118, 16, v177
    v_and_b32 v119, 0xffff0000, v177
    v_lshlrev_b32 v120, 16, v178
    v_and_b32 v121, 0xffff0000, v178
    v_lshlrev_b32 v122, 16, v179
    v_and_b32 v123, 0xffff0000, v179
    v_fmac_f32 v108, v116, v228
    v_fmac_f32 v109, v117, v229
    v_fmac_f32 v110, v118, v230
    v_fmac_f32 v111, v119, v231
    v_fmac_f32 v112, v120, v232
    v_fmac_f32 v113, v121, v233
    v_fmac_f32 v114, v122, v234
    v_fmac_f32 v115, v123, v235
    v_cvt_pk_bf16_f32 v160, v108, v109
    v_cvt_pk_bf16_f32 v161, v110, v111
    v_cvt_pk_bf16_f32 v162, v112, v113
    v_cvt_pk_bf16_f32 v163, v114, v115
    s_nop 0
    v_permlane16_swap_b32 v160, v162
    v_permlane16_swap_b32 v161, v163
    s_mov_b32 s3, 98304
    buffer_store_dwordx4 v[160:163], v17, s[40:43], s3 offen
    s_endpgm
L_s4b:
    s_waitcnt vmcnt(0)
    v_mov_b32 v12, s53
    v_mov_b32 v13, s53
    v_mov_b32 v14, s53
    v_mov_b32 v15, s53
    s_mov_b64 exec, 0xff
    buffer_store_dwordx4 v[12:15], v9, s[36:39], s67 offen sc1
    s_mov_b64 exec, -1
    s_cmp_lt_u32 s21, 16
    s_cbranch_scc1 L_s4br
    s_add_u32 s3, s71, 0
    buffer_store_dwordx4 v[212:215], v221, s[36:39], s3 offen sc1
    s_add_u32 s3, s71, 4096
    buffer_store_dwordx4 v[216:219], v221, s[36:39], s3 offen sc1
    s_mov_b32 s21, 15
    s_mov_b32 s67, s51
    s_branch L_s4br
L_b2:
    s_waitcnt lgkmcnt(0)
    s_barrier
    ds_read_b128 v[224:227], v14 offset:0
    ds_read_b128 v[228:231], v14 offset:4096
    ds_read_b128 v[232:235], v14 offset:8192
    ds_read_b128 v[236:239], v14 offset:12288
    v_add_u32 v248, 9437184, v15
    s_waitcnt lgkmcnt(0)
    s_barrier
    s_and_b32 s11, s66, 3
    s_cmp_eq_u32 s11, s10
    s_cselect_b32 s11, 4, 0
    s_add_u32 s11, s11, s66
    s_and_b32 s11, s11, 15
    s_add_u32 s66, s66, 1
    s_mul_i32 s11, s11, 458752
    s_add_u32 m0, s68, 0
    s_nop 0
    buffer_load_dwordx4 v204, s[40:43], s11 offen offset:0  lds
    buffer_load_dwordx4 v205, s[40:43], s11 offen offset:1024  lds
    s_add_u32 m0, s68, 8192
    s_nop 0
    buffer_load_dwordx4 v206, s[40:43], s11 offen offset:0  lds
    buffer_load_dwordx4 v207, s[40:43], s11 offen offset:1024  lds
    s_add_u32 m0, s68, 16384
    s_nop 0
    buffer_load_dwordx4 v208, s[40:43], s11 offen offset:0  lds
    buffer_load_dwordx4 v209, s[40:43], s11 offen offset:1024  lds
    s_add_u32 m0, s68, s69
    s_nop 0
    buffer_load_dwordx4 v210, s[40:43], s11 offen  lds
    s_add_u32 s68, s68, 28672
    s_cmp_eq_u32 s68, s71
    s_cselect_b32 s3, 86016, 0
    s_sub_u32 s68, s68, s3
    s_and_b32 s11, s66, 3
    s_cmp_eq_u32 s11, s10
    s_cselect_b32 s11, 4, 0
    s_add_u32 s11, s11, s66
    s_and_b32 s11, s11, 15
    s_add_u32 s66, s66, 1
    s_mul_i32 s11, s11, 458752
    s_add_u32 m0, s68, 0
    s_nop 0
    buffer_load_dwordx4 v204, s[40:43], s11 offen offset:0  lds
    buffer_load_dwordx4 v205, s[40:43], s11 offen offset:1024  lds
    s_add_u32 m0, s68, 8192
    s_nop 0
    buffer_load_dwordx4 v206, s[40:43], s11 offen offset:0  lds
    buffer_load_dwordx4 v207, s[40:43], s11 offen offset:1024  lds
    s_add_u32 m0, s68, 16384
    s_nop 0
    buffer_load_dwordx4 v208, s[40:43], s11 offen offset:0  lds
    buffer_load_dwordx4 v209, s[40:43], s11 offen offset:1024  lds
    s_add_u32 m0, s68, s69
    s_nop 0
    buffer_load_dwordx4 v210, s[40:43], s11 offen  lds
    s_add_u32 s68, s68, 28672
    s_cmp_eq_u32 s68, s71
    s_cselect_b32 s3, 86016, 0
    s_sub_u32 s68, s68, s3
    v_and_b32 v47, 15, v2
    v_lshlrev_b32 v47, 7, v47
    s_lshl_b32 s3, s60, 13
    s_lshl_b32 s57, s64, 11
    s_add_u32 s3, s3, s57
    s_add_u32 s3, s3, 131072
    s_mov_b32 s57, 0
poll_18:
    buffer_load_dword v48, v47, s[36:39], s3 offen sc1
    s_waitcnt vmcnt(0)
    v_cmp_ne_u32 vcc, s53, v48
    s_nop 1
    s_cbranch_vccz pdone_19
    s_add_u32 s57, s57, 1
    s_cmp_lt_u32 s57, 0x40000
    s_cbranch_scc1 poll_18
pdone_19:
    s_or_b32 s3, s2, s64
    s_cmp_lg_u32 s3, 0
    s_cbranch_scc1 L_noepoch
    v_mov_b32 v52, s53
    v_mov_b32 v53, s53
    v_mov_b32 v54, s53
    v_mov_b32 v55, s53
    s_mov_b64 exec, 0xff
    buffer_store_dwordx4 v[52:55], v11, s[36:39], 0 offen sc1
    s_mov_b64 exec, -1
    s_waitcnt vmcnt(0)
L_noepoch:
    s_and_b32 s11, s65, 3
    s_cmp_eq_u32 s11, s10
    s_cselect_b32 s11, 4, 0
    s_add_u32 s11, s11, s65
    s_and_b32 s11, s11, 15
    s_add_u32 s65, s65, 1
    s_mov_b32 m0, s67
    s_lshl_b32 s11, s11, 18
    buffer_load_dwordx4 v200, s[36:39], s11 offen offset:0 sc1 lds
    buffer_load_dwordx4 v200, s[36:39], s11 offen offset:1024 sc1 lds
    buffer_load_dwordx4 v200, s[36:39], s11 offen offset:2048 sc1 lds
    buffer_load_dwordx4 v200, s[36:39], s11 offen offset:3072 sc1 lds
    s_add_u32 s67, s67, 16384
    s_cmp_eq_u32 s67, s70
    s_cselect_b32 s3, 49152, 0
    s_sub_u32 s67, s67, s3
    s_and_b32 s11, s65, 3
    s_cmp_eq_u32 s11, s10
    s_cselect_b32 s11, 4, 0
    s_add_u32 s11, s11, s65
    s_and_b32 s11, s11, 15
    s_add_u32 s65, s65, 1
    s_mov_b32 m0, s67
    s_lshl_b32 s11, s11, 18
    buffer_load_dwordx4 v200, s[36:39], s11 offen offset:0 sc1 lds
    buffer_load_dwordx4 v200, s[36:39], s11 offen offset:1024 sc1 lds
    buffer_load_dwordx4 v200, s[36:39], s11 offen offset:2048 sc1 lds
    buffer_load_dwordx4 v200, s[36:39], s11 offen offset:3072 sc1 lds
    s_add_u32 s67, s67, 16384
    s_cmp_eq_u32 s67, s70
    s_cselect_b32 s3, 49152, 0
    s_sub_u32 s67, s67, s3
    s_waitcnt vmcnt(4)
    s_barrier
    s_and_b32 s11, s66, 3
    s_cmp_eq_u32 s11, s10
    s_cselect_b32 s11, 4, 0
    s_add_u32 s11, s11, s66
    s_and_b32 s11, s11, 15
    s_add_u32 s66, s66, 1
    s_mul_i32 s11, s11, 458752
    s_add_u32 m0, s68, 0
    s_nop 0
    buffer_load_dwordx4 v204, s[40:43], s11 offen offset:0  lds
    buffer_load_dwordx4 v205, s[40:43], s11 offen offset:1024  lds
    s_add_u32 m0, s68, 8192
    s_nop 0
    buffer_load_dwordx4 v206, s[40:43], s11 offen offset:0  lds
    buffer_load_dwordx4 v207, s[40:43], s11 offen offset:1024  lds
    s_add_u32 m0, s68, 16384
    s_nop 0
    buffer_load_dwordx4 v208, s[40:43], s11 offen offset:0  lds
    buffer_load_dwordx4 v209, s[40:43], s11 offen offset:1024  lds
    s_add_u32 m0, s68, s69
    s_nop 0
    buffer_load_dwordx4 v210, s[40:43], s11 offen  lds
    s_add_u32 s68, s68, 28672
    s_cmp_eq_u32 s68, s71
    s_cselect_b32 s3, 86016, 0
    s_sub_u32 s68, s68, s3
    s_and_b32 s11, s65, 3
    s_cmp_eq_u32 s11, s10
    s_cselect_b32 s11, 4, 0
    s_add_u32 s11, s11, s65
    s_and_b32 s11, s11, 15
    s_add_u32 s65, s65, 1
    s_mov_b32 m0, s67
    s_lshl_b32 s11, s11, 18
    buffer_load_dwordx4 v200, s[36:39], s11 offen offset:0 sc1 lds
    buffer_load_dwordx4 v200, s[36:39], s11 offen offset:1024 sc1 lds
    buffer_load_dwordx4 v200, s[36:39], s11 offen offset:2048 sc1 lds
    buffer_load_dwordx4 v200, s[36:39], s11 offen offset:3072 sc1 lds
    s_add_u32 s67, s67, 16384
    s_cmp_eq_u32 s67, s70
    s_cselect_b32 s3, 49152, 0
    s_sub_u32 s67, s67, s3
    s_mov_b32 s44, s22
    s_mov_b32 s45, s23
    s_mov_b32 s46, 7340032
    s_mov_b32 s47, 0x20000
    s_mul_i32 s48, s2, 224
    s_mul_i32 s57, s64, 56
    s_add_u32 s48, s48, s57
    s_lshl_b32 s48, s48, 7
    v_min_u32 v50, 55, v2
    v_lshlrev_b32 v50, 7, v50
    s_lshr_b32 s49, s2, 3
    s_and_b32 s49, s49, 7
    s_add_u32 s49, s49, 2
    s_add_u32 s3, s49, 6
    s_lshl_b32 s3, s3, 3
    s_and_b32 s57, s2, 1
    s_lshl_b32 s57, s57, 2
    s_add_u32 s3, s3, s57
    s_lshr_b32 s57, s2, 6
    s_add_u32 s3, s3, s57
    s_lshl_b32 s3, s3, 2
    s_add_u32 s3, s3, s64
    s_lshl_b32 s3, s3, 1
    v_bfe_u32 v52, v2, 4, 1
    v_add_u32 v52, s3, v52
    s_movk_i32 s3, 7168
    v_mul_lo_u32 v52, v52, s3
    v_and_b32 v53, 15, v2
    v_min_u32 v53, 13, v53
    v_lshl_add_u32 v52, v53, 7, v52
    s_bfe_u32 s50, s2, 0x20001
    s_mul_i32 s50, s50, 1792
    s_mov_b32 s59, 0
ploop_20:
    s_waitcnt vmcnt(11)
    s_barrier
    s_and_b32 s11, s66, 3
    s_cmp_eq_u32 s11, s10
    s_cselect_b32 s11, 4, 0
    s_add_u32 s11, s11, s66
    s_and_b32 s11, s11, 15
    s_add_u32 s66, s66, 1
    s_mul_i32 s11, s11, 458752
    s_add_u32 m0, s68, 0
    s_nop 0
    buffer_load_dwordx4 v204, s[40:43], s11 offen offset:0  lds
    buffer_load_dwordx4 v205, s[40:43], s11 offen offset:1024  lds
    s_add_u32 m0, s68, 8192
    s_nop 0
    buffer_load_dwordx4 v206, s[40:43], s11 offen offset:0  lds
    buffer_load_dwordx4 v207, s[40:43], s11 offen offset:1024  lds
    s_add_u32 m0, s68, 16384
    s_nop 0
    buffer_load_dwordx4 v208, s[40:43], s11 offen offset:0  lds
    buffer_load_dwordx4 v209, s[40:43], s11 offen offset:1024  lds
    s_add_u32 m0, s68, s69
    s_nop 0
    buffer_load_dwordx4 v210, s[40:43], s11 offen  lds
    s_add_u32 s68, s68, 28672
    s_cmp_eq_u32 s68, s71
    s_cselect_b32 s3, 86016, 0
    s_sub_u32 s68, s68, s3
    s_and_b32 s11, s65, 3
    s_cmp_eq_u32 s11, s10
    s_cselect_b32 s11, 4, 0
    s_add_u32 s11, s11, s65
    s_and_b32 s11, s11, 15
    s_add_u32 s65, s65, 1
    s_mov_b32 m0, s67
    s_lshl_b32 s11, s11, 18
    buffer_load_dwordx4 v200, s[36:39], s11 offen offset:0 sc1 lds
    buffer_load_dwordx4 v200, s[36:39], s11 offen offset:1024 sc1 lds
    buffer_load_dwordx4 v200, s[36:39], s11 offen offset:2048 sc1 lds
    buffer_load_dwordx4 v200, s[36:39], s11 offen offset:3072 sc1 lds
    s_add_u32 s67, s67, 16384
    s_cmp_eq_u32 s67, s70
    s_cselect_b32 s3, 49152, 0
    s_sub_u32 s67, s67, s3
    s_cmp_lg_u32 s59, s49
    s_cbranch_scc1 pnp_21
    buffer_load_dword v51, v50, s[44:47], s48 offen
pnp_21:
    s_add_u32 s59, s59, 1
    s_cmp_lg_u32 s59, 13
    s_cbranch_scc1 ploop_20
    s_and_b32 s57, s2, 7
    s_lshr_b32 s58, s2, 3
    s_lshr_b32 s60, s57, 1
    s_lshl_b32 s60, s60, 2
    s_and_b32 s3, s58, 3
    s_add_u32 s60, s60, s3
    s_and_b32 s61, s57, 1
    s_lshr_b32 s62, s58, 2
    s_lshl_b32 s62, s62, 8
    s_lshl_b32 s3, s61, 7
    s_add_u32 s62, s62, s3
    s_xor_b32 s63, s62, 128
    s_lshl_b32 s3, s60, 3
    s_lshl_b32 s57, s64, 1
    s_add_u32 s3, s3, s57
    s_lshl_b32 s3, s3, 11
    s_add_u32 s3, s3, 17825792
    v_lshlrev_b32 v200, 4, v2
    v_add_u32 v200, s3, v200
    v_lshrrev_b32 v212, 3, v2
    v_lshrrev_b32 v213, 1, v212
    v_lshlrev_b32 v213, 1, v213
    v_and_b32 v214, 7, v2
    v_xor_b32 v213, v213, v214
    v_lshlrev_b32 v213, 4, v213
    s_movk_i32 s3, 2048
    v_mul_lo_u32 v212, v212, s3
    v_add_u32 v212, v212, v213
    s_lshl_b32 s3, s64, 15
    v_add_u32 v212, s3, v212
    v_add_u32 v204, s62, v212
    v_add_u32 v205, 15360, v204
    v_add_u32 v206, s63, v212
    v_add_u32 v207, 15360, v206
    s_mul_i32 s65, s61, 7340032
    s_mul_i32 s66, s61, 3670016
    s_lshl_b32 s67, s64, 12
    s_add_u32 s67, s67, 94208
    s_lshl_b32 s68, s64, 11
    s_add_u32 s68, s68, 28672
    s_mov_b32 s40, s22
    s_mov_b32 s41, s23
    s_mov_b32 s42, 7340032
    s_mov_b32 s43, 0x20000
    v_and_b32 v46, 15, v2
    v_lshlrev_b32 v46, 8, v46
    v_and_b32 v47, 31, v2
    v_lshlrev_b32 v47, 8, v47
    s_lshr_b32 s3, s64, 1
    s_lshl_b32 s3, s3, 7
    s_lshl_b32 s49, s60, 13
    s_add_u32 s49, s49, s3
    s_lshl_b32 s3, s61, 12
    s_add_u32 s59, s49, s3
    s_add_u32 s59, s59, 262144
    s_add_u32 s71, s49, 524288
    s_add_u32 s49, s49, 41943040
    s_lshr_b32 s3, s2, 5
    s_add_u32 s45, s60, s3
    s_and_b32 s45, s45, 3
    s_waitcnt vmcnt(11)
    s_barrier
    s_mov_b32 s3, 0
    buffer_store_dwordx4 v[224:227], v248, s[36:39], s3 offen sc1
    s_mov_b32 s3, 1048576
    buffer_store_dwordx4 v[228:231], v248, s[36:39], s3 offen sc1
    s_mov_b32 s3, 2097152
    buffer_store_dwordx4 v[232:235], v248, s[36:39], s3 offen sc1
    s_mov_b32 s3, 3145728
    buffer_store_dwordx4 v[236:239], v248, s[36:39], s3 offen sc1
    s_cmp_eq_u32 s45, 0
    s_cselect_b32 s69, 15, 1
    s_lshl_b32 s69, s69, 17
    s_add_u32 s69, s69, s66
    s_add_u32 m0, s68, 0
    s_nop 0
    buffer_load_dwordx4 v204, s[40:43], s69 offen offset:0  lds
    buffer_load_dwordx4 v205, s[40:43], s69 offen offset:1024  lds
    s_add_u32 m0, s68, 8192
    s_nop 0
    buffer_load_dwordx4 v206, s[40:43], s69 offen offset:0  lds
    buffer_load_dwordx4 v207, s[40:43], s69 offen offset:1024  lds
    s_waitcnt vmcnt(8)
    s_barrier
    s_cmp_eq_u32 s45, 1
    s_cselect_b32 s69, 19, 5
    s_lshl_b32 s69, s69, 17
    s_add_u32 s69, s69, s66
    s_add_u32 m0, s68, 16384
    s_nop 0
    buffer_load_dwordx4 v204, s[40:43], s69 offen offset:0  lds
    buffer_load_dwordx4 v205, s[40:43], s69 offen offset:1024  lds
    s_add_u32 m0, s68, 24576
    s_nop 0
    buffer_load_dwordx4 v206, s[40:43], s69 offen offset:0  lds
    buffer_load_dwordx4 v207, s[40:43], s69 offen offset:1024  lds
    s_cmp_eq_u32 s45, 2
    s_cselect_b32 s69, 22, 8
    s_lshl_b32 s69, s69, 17
    s_add_u32 s69, s69, s66
    s_add_u32 m0, s68, 32768
    s_nop 0
    buffer_load_dwordx4 v204, s[40:43], s69 offen offset:0  lds
    buffer_load_dwordx4 v205, s[40:43], s69 offen offset:1024  lds
    s_add_u32 m0, s68, 40960
    s_nop 0
    buffer_load_dwordx4 v206, s[40:43], s69 offen offset:0  lds
    buffer_load_dwordx4 v207, s[40:43], s69 offen offset:1024  lds
    s_barrier
    s_cmp_eq_u32 s45, 3
    s_cselect_b32 s69, 26, 12
    s_lshl_b32 s69, s69, 17
    s_add_u32 s69, s69, s66
    s_add_u32 m0, s68, 49152
    s_nop 0
    buffer_load_dwordx4 v204, s[40:43], s69 offen offset:0  lds
    buffer_load_dwordx4 v205, s[40:43], s69 offen offset:1024  lds
    s_add_u32 m0, s68, 57344
    s_nop 0
    buffer_load_dwordx4 v206, s[40:43], s69 offen offset:0  lds
    buffer_load_dwordx4 v207, s[40:43], s69 offen offset:1024  lds
    v_mov_b32 v48, 163020
wef_22:
    s_sleep 1
    ds_read_b32 v49, v48
    s_waitcnt lgkmcnt(0)
    v_readfirstlane_b32 s57, v49
    s_nop 0
    s_cmp_eq_u32 s57, 0
    s_cbranch_scc1 wef_22
    s_mov_b32 s57, 0
poll_23:
    buffer_load_dword v48, v46, s[36:39], s59 offen sc1
    s_waitcnt vmcnt(0)
    v_cmp_ne_u32 vcc, s53, v48
    s_nop 1
    s_cbranch_vccz pdone_24
    s_add_u32 s57, s57, 1
    s_cmp_lt_u32 s57, 0x40000
    s_cbranch_scc1 poll_23
pdone_24:
    s_add_u32 m0, s67, 0
    s_cmp_eq_u32 s45, 0
    s_cselect_b32 s70, 15, 1
    s_lshl_b32 s70, s70, 18
    s_add_u32 s70, s70, s65
    buffer_load_dwordx4 v200, s[36:39], s70 offen offset:0 sc1 lds
    buffer_load_dwordx4 v200, s[36:39], s70 offen offset:1024 sc1 lds
    buffer_load_dwordx4 v200, s[36:39], s70 offen offset:2048 sc1 lds
    buffer_load_dwordx4 v200, s[36:39], s70 offen offset:3072 sc1 lds
    s_add_u32 m0, s67, 16384
    s_cmp_eq_u32 s45, 1
    s_cselect_b32 s70, 19, 5
    s_lshl_b32 s70, s70, 18
    s_add_u32 s70, s70, s65
    buffer_load_dwordx4 v200, s[36:39], s70 offen offset:0 sc1 lds
    buffer_load_dwordx4 v200, s[36:39], s70 offen offset:1024 sc1 lds
    buffer_load_dwordx4 v200, s[36:39], s70 offen offset:2048 sc1 lds
    buffer_load_dwordx4 v200, s[36:39], s70 offen offset:3072 sc1 lds
    s_waitcnt vmcnt(4)
    s_barrier
    s_add_u32 m0, s67, 32768
    s_cmp_eq_u32 s45, 2
    s_cselect_b32 s70, 22, 8
    s_lshl_b32 s70, s70, 18
    s_add_u32 s70, s70, s65
    buffer_load_dwordx4 v200, s[36:39], s70 offen offset:0 sc1 lds
    buffer_load_dwordx4 v200, s[36:39], s70 offen offset:1024 sc1 lds
    buffer_load_dwordx4 v200, s[36:39], s70 offen offset:2048 sc1 lds
    buffer_load_dwordx4 v200, s[36:39], s70 offen offset:3072 sc1 lds
    s_add_u32 m0, s67, 49152
    s_cmp_eq_u32 s45, 3
    s_cselect_b32 s70, 26, 12
    s_lshl_b32 s70, s70, 18
    s_add_u32 s70, s70, s65
    buffer_load_dwordx4 v200, s[36:39], s70 offen offset:0 sc1 lds
    buffer_load_dwordx4 v200, s[36:39], s70 offen offset:1024 sc1 lds
    buffer_load_dwordx4 v200, s[36:39], s70 offen offset:2048 sc1 lds
    buffer_load_dwordx4 v200, s[36:39], s70 offen offset:3072 sc1 lds
    s_waitcnt vmcnt(8)
    s_barrier
    s_cmp_eq_u32 s45, 0
    s_cselect_b32 s69, 1, 15
    s_lshl_b32 s69, s69, 17
    s_add_u32 s69, s69, s66
    s_add_u32 m0, s68, 0
    s_nop 0
    buffer_load_dwordx4 v204, s[40:43], s69 offen offset:0  lds
    buffer_load_dwordx4 v205, s[40:43], s69 offen offset:1024  lds
    s_add_u32 m0, s68, 8192
    s_nop 0
    buffer_load_dwordx4 v206, s[40:43], s69 offen offset:0  lds
    buffer_load_dwordx4 v207, s[40:43], s69 offen offset:1024  lds
    s_add_u32 m0, s67, 0
    s_cmp_eq_u32 s45, 0
    s_cselect_b32 s70, 1, 15
    s_lshl_b32 s70, s70, 18
    s_add_u32 s70, s70, s65
    buffer_load_dwordx4 v200, s[36:39], s70 offen offset:0 sc1 lds
    buffer_load_dwordx4 v200, s[36:39], s70 offen offset:1024 sc1 lds
    buffer_load_dwordx4 v200, s[36:39], s70 offen offset:2048 sc1 lds
    buffer_load_dwordx4 v200, s[36:39], s70 offen offset:3072 sc1 lds
    s_waitcnt vmcnt(12)
    s_barrier
    s_cmp_eq_u32 s45, 1
    s_cselect_b32 s69, 5, 19
    s_lshl_b32 s69, s69, 17
    s_add_u32 s69, s69, s66
    s_add_u32 m0, s68, 16384
    s_nop 0
    buffer_load_dwordx4 v204, s[40:43], s69 offen offset:0  lds
    buffer_load_dwordx4 v205, s[40:43], s69 offen offset:1024  lds
    s_add_u32 m0, s68, 24576
    s_nop 0
    buffer_load_dwordx4 v206, s[40:43], s69 offen offset:0  lds
    buffer_load_dwordx4 v207, s[40:43], s69 offen offset:1024  lds
    s_add_u32 m0, s67, 16384
    s_cmp_eq_u32 s45, 1
    s_cselect_b32 s70, 5, 19
    s_lshl_b32 s70, s70, 18
    s_add_u32 s70, s70, s65
    buffer_load_dwordx4 v200, s[36:39], s70 offen offset:0 sc1 lds
    buffer_load_dwordx4 v200, s[36:39], s70 offen offset:1024 sc1 lds
    buffer_load_dwordx4 v200, s[36:39], s70 offen offset:2048 sc1 lds
    buffer_load_dwordx4 v200, s[36:39], s70 offen offset:3072 sc1 lds
    s_waitcnt vmcnt(16)
    s_barrier
    s_cmp_eq_u32 s45, 2
    s_cselect_b32 s69, 8, 22
    s_lshl_b32 s69, s69, 17
    s_add_u32 s69, s69, s66
    s_add_u32 m0, s68, 32768
    s_nop 0
    buffer_load_dwordx4 v204, s[40:43], s69 offen offset:0  lds
    buffer_load_dwordx4 v205, s[40:43], s69 offen offset:1024  lds
    s_add_u32 m0, s68, 40960
    s_nop 0
    buffer_load_dwordx4 v206, s[40:43], s69 offen offset:0  lds
    buffer_load_dwordx4 v207, s[40:43], s69 offen offset:1024  lds
    s_add_u32 m0, s67, 32768
    s_cmp_eq_u32 s45, 2
    s_cselect_b32 s70, 8, 22
    s_lshl_b32 s70, s70, 18
    s_add_u32 s70, s70, s65
    buffer_load_dwordx4 v200, s[36:39], s70 offen offset:0 sc1 lds
    buffer_load_dwordx4 v200, s[36:39], s70 offen offset:1024 sc1 lds
    buffer_load_dwordx4 v200, s[36:39], s70 offen offset:2048 sc1 lds
    buffer_load_dwordx4 v200, s[36:39], s70 offen offset:3072 sc1 lds
    s_waitcnt vmcnt(16)
    s_barrier
    buffer_load_dword v48, v47, s[36:39], s71 offen sc1
    s_cmp_eq_u32 s45, 3
    s_cselect_b32 s69, 12, 26
    s_lshl_b32 s69, s69, 17
    s_add_u32 s69, s69, s66
    s_add_u32 m0, s68, 49152
    s_nop 0
    buffer_load_dwordx4 v204, s[40:43], s69 offen offset:0  lds
    buffer_load_dwordx4 v205, s[40:43], s69 offen offset:1024  lds
    s_add_u32 m0, s68, 57344
    s_nop 0
    buffer_load_dwordx4 v206, s[40:43], s69 offen offset:0  lds
    buffer_load_dwordx4 v207, s[40:43], s69 offen offset:1024  lds
    s_add_u32 m0, s67, 49152
    s_cmp_eq_u32 s45, 3
    s_cselect_b32 s70, 12, 26
    s_lshl_b32 s70, s70, 18
    s_add_u32 s70, s70, s65
    buffer_load_dwordx4 v200, s[36:39], s70 offen offset:0 sc1 lds
    buffer_load_dwordx4 v200, s[36:39], s70 offen offset:1024 sc1 lds
    buffer_load_dwordx4 v200, s[36:39], s70 offen offset:2048 sc1 lds
    buffer_load_dwordx4 v200, s[36:39], s70 offen offset:3072 sc1 lds
    s_waitcnt vmcnt(17)
    s_barrier
    s_waitcnt vmcnt(8)
    v_cmp_ne_u32 vcc, s53, v48
    s_nop 1
    s_cbranch_vccz s4ok_25
    s_mov_b32 s57, 0
poll_26:
    buffer_load_dword v48, v47, s[36:39], s71 offen sc1
    s_waitcnt vmcnt(0)
    v_cmp_ne_u32 vcc, s53, v48
    s_nop 1
    s_cbranch_vccz pdone_27
    s_add_u32 s57, s57, 1
    s_cmp_lt_u32 s57, 0x40000
    s_cbranch_scc1 poll_26
pdone_27:
s4ok_25:
    s_cmp_eq_u32 s45, 0
    s_cselect_b32 s69, 7, 0
    s_lshl_b32 s69, s69, 17
    s_add_u32 s69, s69, s66
    s_add_u32 m0, s68, 0
    s_nop 0
    buffer_load_dwordx4 v204, s[40:43], s69 offen offset:0  lds
    buffer_load_dwordx4 v205, s[40:43], s69 offen offset:1024  lds
    s_add_u32 m0, s68, 8192
    s_nop 0
    buffer_load_dwordx4 v206, s[40:43], s69 offen offset:0  lds
    buffer_load_dwordx4 v207, s[40:43], s69 offen offset:1024  lds
    s_add_u32 m0, s67, 0
    s_cmp_eq_u32 s45, 0
    s_cselect_b32 s70, 7, 0
    s_lshl_b32 s70, s70, 18
    s_add_u32 s70, s70, s65
    buffer_load_dwordx4 v200, s[36:39], s70 offen offset:0 sc1 lds
    buffer_load_dwordx4 v200, s[36:39], s70 offen offset:1024 sc1 lds
    buffer_load_dwordx4 v200, s[36:39], s70 offen offset:2048 sc1 lds
    buffer_load_dwordx4 v200, s[36:39], s70 offen offset:3072 sc1 lds
    s_waitcnt vmcnt(17)
    s_barrier
    s_cmp_eq_u32 s45, 1
    s_cselect_b32 s69, 9, 2
    s_lshl_b32 s69, s69, 17
    s_add_u32 s69, s69, s66
    s_add_u32 m0, s68, 16384
    s_nop 0
    buffer_load_dwordx4 v204, s[40:43], s69 offen offset:0  lds
    buffer_load_dwordx4 v205, s[40:43], s69 offen offset:1024  lds
    s_add_u32 m0, s68, 24576
    s_nop 0
    buffer_load_dwordx4 v206, s[40:43], s69 offen offset:0  lds
    buffer_load_dwordx4 v207, s[40:43], s69 offen offset:1024  lds
    s_add_u32 m0, s67, 16384
    s_cmp_eq_u32 s45, 1
    s_cselect_b32 s70, 9, 2
    s_lshl_b32 s70, s70, 18
    s_add_u32 s70, s70, s65
    buffer_load_dwordx4 v200, s[36:39], s70 offen offset:0 sc1 lds
    buffer_load_dwordx4 v200, s[36:39], s70 offen offset:1024 sc1 lds
    buffer_load_dwordx4 v200, s[36:39], s70 offen offset:2048 sc1 lds
    buffer_load_dwordx4 v200, s[36:39], s70 offen offset:3072 sc1 lds
    s_waitcnt vmcnt(16)
    s_barrier
    s_cmp_eq_u32 s45, 2
    s_cselect_b32 s69, 11, 4
    s_lshl_b32 s69, s69, 17
    s_add_u32 s69, s69, s66
    s_add_u32 m0, s68, 32768
    s_nop 0
    buffer_load_dwordx4 v204, s[40:43], s69 offen offset:0  lds
    buffer_load_dwordx4 v205, s[40:43], s69 offen offset:1024  lds
    s_add_u32 m0, s68, 40960
    s_nop 0
    buffer_load_dwordx4 v206, s[40:43], s69 offen offset:0  lds
    buffer_load_dwordx4 v207, s[40:43], s69 offen offset:1024  lds
    s_add_u32 m0, s67, 32768
    s_cmp_eq_u32 s45, 2
    s_cselect_b32 s70, 11, 4
    s_lshl_b32 s70, s70, 18
    s_add_u32 s70, s70, s65
    buffer_load_dwordx4 v200, s[36:39], s70 offen offset:0 sc1 lds
    buffer_load_dwordx4 v200, s[36:39], s70 offen offset:1024 sc1 lds
    buffer_load_dwordx4 v200, s[36:39], s70 offen offset:2048 sc1 lds
    buffer_load_dwordx4 v200, s[36:39], s70 offen offset:3072 sc1 lds
    s_waitcnt vmcnt(16)
    s_barrier
    s_cmp_eq_u32 s45, 3
    s_cselect_b32 s69, 13, 6
    s_lshl_b32 s69, s69, 17
    s_add_u32 s69, s69, s66
    s_add_u32 m0, s68, 49152
    s_nop 0
    buffer_load_dwordx4 v204, s[40:43], s69 offen offset:0  lds
    buffer_load_dwordx4 v205, s[40:43], s69 offen offset:1024  lds
    s_add_u32 m0, s68, 57344
    s_nop 0
    buffer_load_dwordx4 v206, s[40:43], s69 offen offset:0  lds
    buffer_load_dwordx4 v207, s[40:43], s69 offen offset:1024  lds
    s_add_u32 m0, s67, 49152
    s_cmp_eq_u32 s45, 3
    s_cselect_b32 s70, 13, 6
    s_lshl_b32 s70, s70, 18
    s_add_u32 s70, s70, s65
    buffer_load_dwordx4 v200, s[36:39], s70 offen offset:0 sc1 lds
    buffer_load_dwordx4 v200, s[36:39], s70 offen offset:1024 sc1 lds
    buffer_load_dwordx4 v200, s[36:39], s70 offen offset:2048 sc1 lds
    buffer_load_dwordx4 v200, s[36:39], s70 offen offset:3072 sc1 lds
    s_waitcnt vmcnt(16)
    s_barrier
    s_cmp_eq_u32 s45, 0
    s_cselect_b32 s69, 14, 7
    s_lshl_b32 s69, s69, 17
    s_add_u32 s69, s69, s66
    s_add_u32 m0, s68, 0
    s_nop 0
    buffer_load_dwordx4 v204, s[40:43], s69 offen offset:0  lds
    buffer_load_dwordx4 v205, s[40:43], s69 offen offset:1024  lds
    s_add_u32 m0, s68, 8192
    s_nop 0
    buffer_load_dwordx4 v206, s[40:43], s69 offen offset:0  lds
    buffer_load_dwordx4 v207, s[40:43], s69 offen offset:1024  lds
    s_add_u32 m0, s67, 0
    s_cmp_eq_u32 s45, 0
    s_cselect_b32 s70, 14, 7
    s_lshl_b32 s70, s70, 18
    s_add_u32 s70, s70, s65
    buffer_load_dwordx4 v200, s[36:39], s70 offen offset:0 sc1 lds
    buffer_load_dwordx4 v200, s[36:39], s70 offen offset:1024 sc1 lds
    buffer_load_dwordx4 v200, s[36:39], s70 offen offset:2048 sc1 lds
    buffer_load_dwordx4 v200, s[36:39], s70 offen offset:3072 sc1 lds
    s_waitcnt vmcnt(16)
    s_barrier
    s_cmp_eq_u32 s45, 1
    s_cselect_b32 s69, 16, 9
    s_lshl_b32 s69, s69, 17
    s_add_u32 s69, s69, s66
    s_add_u32 m0, s68, 16384
    s_nop 0
    buffer_load_dwordx4 v204, s[40:43], s69 offen offset:0  lds
    buffer_load_dwordx4 v205, s[40:43], s69 offen offset:1024  lds
    s_add_u32 m0, s68, 24576
    s_nop 0
    buffer_load_dwordx4 v206, s[40:43], s69 offen offset:0  lds
    buffer_load_dwordx4 v207, s[40:43], s69 offen offset:1024  lds
    s_add_u32 m0, s67, 16384
    s_cmp_eq_u32 s45, 1
    s_cselect_b32 s70, 16, 9
    s_lshl_b32 s70, s70, 18
    s_add_u32 s70, s70, s65
    buffer_load_dwordx4 v200, s[36:39], s70 offen offset:0 sc1 lds
    buffer_load_dwordx4 v200, s[36:39], s70 offen offset:1024 sc1 lds
    buffer_load_dwordx4 v200, s[36:39], s70 offen offset:2048 sc1 lds
    buffer_load_dwordx4 v200, s[36:39], s70 offen offset:3072 sc1 lds
    s_waitcnt vmcnt(16)
    s_barrier
    s_cmp_eq_u32 s45, 2
    s_cselect_b32 s69, 18, 11
    s_lshl_b32 s69, s69, 17
    s_add_u32 s69, s69, s66
    s_add_u32 m0, s68, 32768
    s_nop 0
    buffer_load_dwordx4 v204, s[40:43], s69 offen offset:0  lds
    buffer_load_dwordx4 v205, s[40:43], s69 offen offset:1024  lds
    s_add_u32 m0, s68, 40960
    s_nop 0
    buffer_load_dwordx4 v206, s[40:43], s69 offen offset:0  lds
    buffer_load_dwordx4 v207, s[40:43], s69 offen offset:1024  lds
    s_add_u32 m0, s67, 32768
    s_cmp_eq_u32 s45, 2
    s_cselect_b32 s70, 18, 11
    s_lshl_b32 s70, s70, 18
    s_add_u32 s70, s70, s65
    buffer_load_dwordx4 v200, s[36:39], s70 offen offset:0 sc1 lds
    buffer_load_dwordx4 v200, s[36:39], s70 offen offset:1024 sc1 lds
    buffer_load_dwordx4 v200, s[36:39], s70 offen offset:2048 sc1 lds
    buffer_load_dwordx4 v200, s[36:39], s70 offen offset:3072 sc1 lds
    s_waitcnt vmcnt(16)
    s_barrier
    s_cmp_eq_u32 s45, 3
    s_cselect_b32 s69, 20, 13
    s_lshl_b32 s69, s69, 17
    s_add_u32 s69, s69, s66
    s_add_u32 m0, s68, 49152
    s_nop 0
    buffer_load_dwordx4 v204, s[40:43], s69 offen offset:0  lds
    buffer_load_dwordx4 v205, s[40:43], s69 offen offset:1024  lds
    s_add_u32 m0, s68, 57344
    s_nop 0
    buffer_load_dwordx4 v206, s[40:43], s69 offen offset:0  lds
    buffer_load_dwordx4 v207, s[40:43], s69 offen offset:1024  lds
    s_add_u32 m0, s67, 49152
    s_cmp_eq_u32 s45, 3
    s_cselect_b32 s70, 20, 13
    s_lshl_b32 s70, s70, 18
    s_add_u32 s70, s70, s65
    buffer_load_dwordx4 v200, s[36:39], s70 offen offset:0 sc1 lds
    buffer_load_dwordx4 v200, s[36:39], s70 offen offset:1024 sc1 lds
    buffer_load_dwordx4 v200, s[36:39], s70 offen offset:2048 sc1 lds
    buffer_load_dwordx4 v200, s[36:39], s70 offen offset:3072 sc1 lds
    s_waitcnt vmcnt(16)
    s_barrier
    s_cmp_eq_u32 s45, 0
    s_cselect_b32 s69, 21, 14
    s_lshl_b32 s69, s69, 17
    s_add_u32 s69, s69, s66
    s_add_u32 m0, s68, 0
    s_nop 0
    buffer_load_dwordx4 v204, s[40:43], s69 offen offset:0  lds
    buffer_load_dwordx4 v205, s[40:43], s69 offen offset:1024  lds
    s_add_u32 m0, s68, 8192
    s_nop 0
    buffer_load_dwordx4 v206, s[40:43], s69 offen offset:0  lds
    buffer_load_dwordx4 v207, s[40:43], s69 offen offset:1024  lds
    s_add_u32 m0, s67, 0
    s_cmp_eq_u32 s45, 0
    s_cselect_b32 s70, 21, 14
    s_lshl_b32 s70, s70, 18
    s_add_u32 s70, s70, s65
    buffer_load_dwordx4 v200, s[36:39], s70 offen offset:0 sc1 lds
    buffer_load_dwordx4 v200, s[36:39], s70 offen offset:1024 sc1 lds
    buffer_load_dwordx4 v200, s[36:39], s70 offen offset:2048 sc1 lds
    buffer_load_dwordx4 v200, s[36:39], s70 offen offset:3072 sc1 lds
    s_waitcnt vmcnt(16)
    s_barrier
    s_cmp_eq_u32 s45, 1
    s_cselect_b32 s69, 23, 16
    s_lshl_b32 s69, s69, 17
    s_add_u32 s69, s69, s66
    s_add_u32 m0, s68, 16384
    s_nop 0
    buffer_load_dwordx4 v204, s[40:43], s69 offen offset:0  lds
    buffer_load_dwordx4 v205, s[40:43], s69 offen offset:1024  lds
    s_add_u32 m0, s68, 24576
    s_nop 0
    buffer_load_dwordx4 v206, s[40:43], s69 offen offset:0  lds
    buffer_load_dwordx4 v207, s[40:43], s69 offen offset:1024  lds
    s_add_u32 m0, s67, 16384
    s_cmp_eq_u32 s45, 1
    s_cselect_b32 s70, 23, 16
    s_lshl_b32 s70, s70, 18
    s_add_u32 s70, s70, s65
    buffer_load_dwordx4 v200, s[36:39], s70 offen offset:0 sc1 lds
    buffer_load_dwordx4 v200, s[36:39], s70 offen offset:1024 sc1 lds
    buffer_load_dwordx4 v200, s[36:39], s70 offen offset:2048 sc1 lds
    buffer_load_dwordx4 v200, s[36:39], s70 offen offset:3072 sc1 lds
    s_waitcnt vmcnt(16)
    s_barrier
    s_cmp_eq_u32 s45, 2
    s_cselect_b32 s69, 25, 18
    s_lshl_b32 s69, s69, 17
    s_add_u32 s69, s69, s66
    s_add_u32 m0, s68, 32768
    s_nop 0
    buffer_load_dwordx4 v204, s[40:43], s69 offen offset:0  lds
    buffer_load_dwordx4 v205, s[40:43], s69 offen offset:1024  lds
    s_add_u32 m0, s68, 40960
    s_nop 0
    buffer_load_dwordx4 v206, s[40:43], s69 offen offset:0  lds
    buffer_load_dwordx4 v207, s[40:43], s69 offen offset:1024  lds
    s_add_u32 m0, s67, 32768
    s_cmp_eq_u32 s45, 2
    s_cselect_b32 s70, 25, 18
    s_lshl_b32 s70, s70, 18
    s_add_u32 s70, s70, s65
    buffer_load_dwordx4 v200, s[36:39], s70 offen offset:0 sc1 lds
    buffer_load_dwordx4 v200, s[36:39], s70 offen offset:1024 sc1 lds
    buffer_load_dwordx4 v200, s[36:39], s70 offen offset:2048 sc1 lds
    buffer_load_dwordx4 v200, s[36:39], s70 offen offset:3072 sc1 lds
    s_waitcnt vmcnt(16)
    s_barrier
    s_cmp_eq_u32 s45, 3
    s_cselect_b32 s69, 27, 20
    s_lshl_b32 s69, s69, 17
    s_add_u32 s69, s69, s66
    s_add_u32 m0, s68, 49152
    s_nop 0
    buffer_load_dwordx4 v204, s[40:43], s69 offen offset:0  lds
    buffer_load_dwordx4 v205, s[40:43], s69 offen offset:1024  lds
    s_add_u32 m0, s68, 57344
    s_nop 0
    buffer_load_dwordx4 v206, s[40:43], s69 offen offset:0  lds
    buffer_load_dwordx4 v207, s[40:43], s69 offen offset:1024  lds
    s_add_u32 m0, s67, 49152
    s_cmp_eq_u32 s45, 3
    s_cselect_b32 s70, 27, 20
    s_lshl_b32 s70, s70, 18
    s_add_u32 s70, s70, s65
    buffer_load_dwordx4 v200, s[36:39], s70 offen offset:0 sc1 lds
    buffer_load_dwordx4 v200, s[36:39], s70 offen offset:1024 sc1 lds
    buffer_load_dwordx4 v200, s[36:39], s70 offen offset:2048 sc1 lds
    buffer_load_dwordx4 v200, s[36:39], s70 offen offset:3072 sc1 lds
    s_waitcnt vmcnt(16)
    s_barrier
    s_cmp_eq_u32 s45, 0
    s_cselect_b32 s69, 0, 21
    s_lshl_b32 s69, s69, 17
    s_add_u32 s69, s69, s66
    s_add_u32 m0, s68, 0
    s_nop 0
    buffer_load_dwordx4 v204, s[40:43], s69 offen offset:0  lds
    buffer_load_dwordx4 v205, s[40:43], s69 offen offset:1024  lds
    s_add_u32 m0, s68, 8192
    s_nop 0
    buffer_load_dwordx4 v206, s[40:43], s69 offen offset:0  lds
    buffer_load_dwordx4 v207, s[40:43], s69 offen offset:1024  lds
    s_add_u32 m0, s67, 0
    s_cmp_eq_u32 s45, 0
    s_cselect_b32 s70, 0, 21
    s_lshl_b32 s70, s70, 18
    s_add_u32 s70, s70, s65
    buffer_load_dwordx4 v200, s[36:39], s70 offen offset:0 sc1 lds
    buffer_load_dwordx4 v200, s[36:39], s70 offen offset:1024 sc1 lds
    buffer_load_dwordx4 v200, s[36:39], s70 offen offset:2048 sc1 lds
    buffer_load_dwordx4 v200, s[36:39], s70 offen offset:3072 sc1 lds
    s_waitcnt vmcnt(16)
    s_barrier
    s_cmp_eq_u32 s45, 1
    s_cselect_b32 s69, 2, 23
    s_lshl_b32 s69, s69, 17
    s_add_u32 s69, s69, s66
    s_add_u32 m0, s68, 16384
    s_nop 0
    buffer_load_dwordx4 v204, s[40:43], s69 offen offset:0  lds
    buffer_load_dwordx4 v205, s[40:43], s69 offen offset:1024  lds
    s_add_u32 m0, s68, 24576
    s_nop 0
    buffer_load_dwordx4 v206, s[40:43], s69 offen offset:0  lds
    buffer_load_dwordx4 v207, s[40:43], s69 offen offset:1024  lds
    s_add_u32 m0, s67, 16384
    s_cmp_eq_u32 s45, 1
    s_cselect_b32 s70, 2, 23
    s_lshl_b32 s70, s70, 18
    s_add_u32 s70, s70, s65
    buffer_load_dwordx4 v200, s[36:39], s70 offen offset:0 sc1 lds
    buffer_load_dwordx4 v200, s[36:39], s70 offen offset:1024 sc1 lds
    buffer_load_dwordx4 v200, s[36:39], s70 offen offset:2048 sc1 lds
    buffer_load_dwordx4 v200, s[36:39], s70 offen offset:3072 sc1 lds
    s_waitcnt vmcnt(16)
    s_barrier
    buffer_load_dword v48, v47, s[36:39], s49 offen sc1
    s_cmp_eq_u32 s45, 2
    s_cselect_b32 s69, 4, 25
    s_lshl_b32 s69, s69, 17
    s_add_u32 s69, s69, s66
    s_add_u32 m0, s68, 32768
    s_nop 0
    buffer_load_dwordx4 v204, s[40:43], s69 offen offset:0  lds
    buffer_load_dwordx4 v205, s[40:43], s69 offen offset:1024  lds
    s_add_u32 m0, s68, 40960
    s_nop 0
    buffer_load_dwordx4 v206, s[40:43], s69 offen offset:0  lds
    buffer_load_dwordx4 v207, s[40:43], s69 offen offset:1024  lds
    s_add_u32 m0, s67, 32768
    s_cmp_eq_u32 s45, 2
    s_cselect_b32 s70, 4, 25
    s_lshl_b32 s70, s70, 18
    s_add_u32 s70, s70, s65
    buffer_load_dwordx4 v200, s[36:39], s70 offen offset:0 sc1 lds
    buffer_load_dwordx4 v200, s[36:39], s70 offen offset:1024 sc1 lds
    buffer_load_dwordx4 v200, s[36:39], s70 offen offset:2048 sc1 lds
    buffer_load_dwordx4 v200, s[36:39], s70 offen offset:3072 sc1 lds
    s_waitcnt vmcnt(17)
    s_barrier
    s_cmp_eq_u32 s45, 3
    s_cselect_b32 s69, 6, 27
    s_lshl_b32 s69, s69, 17
    s_add_u32 s69, s69, s66
    s_add_u32 m0, s68, 49152
    s_nop 0
    buffer_load_dwordx4 v204, s[40:43], s69 offen offset:0  lds
    buffer_load_dwordx4 v205, s[40:43], s69 offen offset:1024  lds
    s_add_u32 m0, s68, 57344
    s_nop 0
    buffer_load_dwordx4 v206, s[40:43], s69 offen offset:0  lds
    buffer_load_dwordx4 v207, s[40:43], s69 offen offset:1024  lds
    s_add_u32 m0, s67, 49152
    s_cmp_eq_u32 s45, 3
    s_cselect_b32 s70, 6, 27
    s_lshl_b32 s70, s70, 18
    s_add_u32 s70, s70, s65
    buffer_load_dwordx4 v200, s[36:39], s70 offen offset:0 sc1 lds
    buffer_load_dwordx4 v200, s[36:39], s70 offen offset:1024 sc1 lds
    buffer_load_dwordx4 v200, s[36:39], s70 offen offset:2048 sc1 lds
    buffer_load_dwordx4 v200, s[36:39], s70 offen offset:3072 sc1 lds
    s_waitcnt vmcnt(17)
    s_barrier
    s_waitcnt vmcnt(16)
    v_cmp_ne_u32 vcc, s53, v48
    s_nop 1
    s_cbranch_vccz s4ok_28
    s_mov_b32 s57, 0
poll_29:
    buffer_load_dword v48, v47, s[36:39], s49 offen sc1
    s_waitcnt vmcnt(0)
    v_cmp_ne_u32 vcc, s53, v48
    s_nop 1
    s_cbranch_vccz pdone_30
    s_add_u32 s57, s57, 1
    s_cmp_lt_u32 s57, 0x40000
    s_cbranch_scc1 poll_29
pdone_30:
s4ok_28:
    s_cmp_eq_u32 s45, 0
    s_cselect_b32 s69, 31, 3
    s_lshl_b32 s69, s69, 17
    s_add_u32 m0, s68, 0
    s_nop 0
    buffer_load_dwordx4 v204, s[40:43], s69 offen offset:0  lds
    buffer_load_dwordx4 v205, s[40:43], s69 offen offset:1024  lds
    s_add_u32 m0, s67, 0
    s_cmp_eq_u32 s45, 0
    s_cselect_b32 s70, 31, 3
    s_lshl_b32 s70, s70, 18
    buffer_load_dwordx4 v200, s[36:39], s70 offen offset:0 sc1 lds
    buffer_load_dwordx4 v200, s[36:39], s70 offen offset:1024 sc1 lds
    buffer_load_dwordx4 v200, s[36:39], s70 offen offset:2048 sc1 lds
    buffer_load_dwordx4 v200, s[36:39], s70 offen offset:3072 sc1 lds
    s_waitcnt vmcnt(14)
    s_barrier
    s_cmp_eq_u32 s45, 1
    s_cselect_b32 s69, 38, 10
    s_lshl_b32 s69, s69, 17
    s_add_u32 m0, s68, 16384
    s_nop 0
    buffer_load_dwordx4 v204, s[40:43], s69 offen offset:0  lds
    buffer_load_dwordx4 v205, s[40:43], s69 offen offset:1024  lds
    s_add_u32 m0, s67, 16384
    s_cmp_eq_u32 s45, 1
    s_cselect_b32 s70, 38, 10
    s_lshl_b32 s70, s70, 18
    buffer_load_dwordx4 v200, s[36:39], s70 offen offset:0 sc1 lds
    buffer_load_dwordx4 v200, s[36:39], s70 offen offset:1024 sc1 lds
    buffer_load_dwordx4 v200, s[36:39], s70 offen offset:2048 sc1 lds
    buffer_load_dwordx4 v200, s[36:39], s70 offen offset:3072 sc1 lds
    s_waitcnt vmcnt(12)
    s_barrier
    s_cmp_eq_u32 s45, 2
    s_cselect_b32 s69, 45, 17
    s_lshl_b32 s69, s69, 17
    s_add_u32 m0, s68, 32768
    s_nop 0
    buffer_load_dwordx4 v204, s[40:43], s69 offen offset:0  lds
    buffer_load_dwordx4 v205, s[40:43], s69 offen offset:1024  lds
    s_add_u32 m0, s67, 32768
    s_cmp_eq_u32 s45, 2
    s_cselect_b32 s70, 45, 17
    s_lshl_b32 s70, s70, 18
    buffer_load_dwordx4 v200, s[36:39], s70 offen offset:0 sc1 lds
    buffer_load_dwordx4 v200, s[36:39], s70 offen offset:1024 sc1 lds
    buffer_load_dwordx4 v200, s[36:39], s70 offen offset:2048 sc1 lds
    buffer_load_dwordx4 v200, s[36:39], s70 offen offset:3072 sc1 lds
    s_waitcnt vmcnt(12)
    s_barrier
    s_cmp_eq_u32 s45, 3
    s_cselect_b32 s69, 52, 24
    s_lshl_b32 s69, s69, 17
    s_add_u32 m0, s68, 49152
    s_nop 0
    buffer_load_dwordx4 v204, s[40:43], s69 offen offset:0  lds
    buffer_load_dwordx4 v205, s[40:43], s69 offen offset:1024  lds
    s_add_u32 m0, s67, 49152
    s_cmp_eq_u32 s45, 3
    s_cselect_b32 s70, 52, 24
    s_lshl_b32 s70, s70, 18
    buffer_load_dwordx4 v200, s[36:39], s70 offen offset:0 sc1 lds
    buffer_load_dwordx4 v200, s[36:39], s70 offen offset:1024 sc1 lds
    buffer_load_dwordx4 v200, s[36:39], s70 offen offset:2048 sc1 lds
    buffer_load_dwordx4 v200, s[36:39], s70 offen offset:3072 sc1 lds
    s_waitcnt vmcnt(12)
    s_barrier
    s_cmp_eq_u32 s45, 0
    s_cselect_b32 s69, 3, 31
    s_lshl_b32 s69, s69, 17
    s_add_u32 m0, s68, 0
    s_nop 0
    buffer_load_dwordx4 v204, s[40:43], s69 offen offset:0  lds
    buffer_load_dwordx4 v205, s[40:43], s69 offen offset:1024  lds
    s_add_u32 m0, s67, 0
    s_cmp_eq_u32 s45, 0
    s_cselect_b32 s70, 3, 31
    s_lshl_b32 s70, s70, 18
    buffer_load_dwordx4 v200, s[36:39], s70 offen offset:0 sc1 lds
    buffer_load_dwordx4 v200, s[36:39], s70 offen offset:1024 sc1 lds
    buffer_load_dwordx4 v200, s[36:39], s70 offen offset:2048 sc1 lds
    buffer_load_dwordx4 v200, s[36:39], s70 offen offset:3072 sc1 lds
    s_waitcnt vmcnt(12)
    s_barrier
    s_cmp_eq_u32 s45, 1
    s_cselect_b32 s69, 10, 38
    s_lshl_b32 s69, s69, 17
    s_add_u32 m0, s68, 16384
    s_nop 0
    buffer_load_dwordx4 v204, s[40:43], s69 offen offset:0  lds
    buffer_load_dwordx4 v205, s[40:43], s69 offen offset:1024  lds
    s_add_u32 m0, s67, 16384
    s_cmp_eq_u32 s45, 1
    s_cselect_b32 s70, 10, 38
    s_lshl_b32 s70, s70, 18
    buffer_load_dwordx4 v200, s[36:39], s70 offen offset:0 sc1 lds
    buffer_load_dwordx4 v200, s[36:39], s70 offen offset:1024 sc1 lds
    buffer_load_dwordx4 v200, s[36:39], s70 offen offset:2048 sc1 lds
    buffer_load_dwordx4 v200, s[36:39], s70 offen offset:3072 sc1 lds
    s_waitcnt vmcnt(12)
    s_barrier
    s_cmp_eq_u32 s45, 2
    s_cselect_b32 s69, 17, 45
    s_lshl_b32 s69, s69, 17
    s_add_u32 m0, s68, 32768
    s_nop 0
    buffer_load_dwordx4 v204, s[40:43], s69 offen offset:0  lds
    buffer_load_dwordx4 v205, s[40:43], s69 offen offset:1024  lds
    s_add_u32 m0, s67, 32768
    s_cmp_eq_u32 s45, 2
    s_cselect_b32 s70, 17, 45
    s_lshl_b32 s70, s70, 18
    buffer_load_dwordx4 v200, s[36:39], s70 offen offset:0 sc1 lds
    buffer_load_dwordx4 v200, s[36:39], s70 offen offset:1024 sc1 lds
    buffer_load_dwordx4 v200, s[36:39], s70 offen offset:2048 sc1 lds
    buffer_load_dwordx4 v200, s[36:39], s70 offen offset:3072 sc1 lds
    s_waitcnt vmcnt(12)
    s_barrier
    s_cmp_eq_u32 s45, 3
    s_cselect_b32 s69, 24, 52
    s_lshl_b32 s69, s69, 17
    s_add_u32 m0, s68, 49152
    s_nop 0
    buffer_load_dwordx4 v204, s[40:43], s69 offen offset:0  lds
    buffer_load_dwordx4 v205, s[40:43], s69 offen offset:1024  lds
    s_add_u32 m0, s67, 49152
    s_cmp_eq_u32 s45, 3
    s_cselect_b32 s70, 24, 52
    s_lshl_b32 s70, s70, 18
    buffer_load_dwordx4 v200, s[36:39], s70 offen offset:0 sc1 lds
    buffer_load_dwordx4 v200, s[36:39], s70 offen offset:1024 sc1 lds
    buffer_load_dwordx4 v200, s[36:39], s70 offen offset:2048 sc1 lds
    buffer_load_dwordx4 v200, s[36:39], s70 offen offset:3072 sc1 lds
    s_waitcnt vmcnt(12)
    s_barrier
    s_waitcnt vmcnt(6)
    s_barrier
    s_waitcnt vmcnt(0)
    s_barrier
    s_barrier
L_exit:
    s_endpgm
L_end:
.section .rodata,"a"
.p2align 6
.amdhsa_kernel adaLN_cond__ssm_conv_h3__mixer_channel_mlp__prompt_kernel
  .amdhsa_next_free_vgpr 256
  .amdhsa_next_free_sgpr 102
  .amdhsa_accum_offset 256
  .amdhsa_group_segment_fixed_size 0
  .amdhsa_kernarg_size 128
  .amdhsa_user_sgpr_count 2
  .amdhsa_user_sgpr_kernarg_segment_ptr 1
  .amdhsa_system_sgpr_workgroup_id_x 1
  .amdhsa_float_denorm_mode_32 3
  .amdhsa_float_denorm_mode_16_64 3
.end_amdhsa_kernel
```
